```python
import torch

def _softmax(x, axis=-1):
    return torch.softmax(x, dim=axis)
def _gelu(x):
    return torch.nn.functional.gelu(x, approximate="tanh")
def _silu(x):
    return torch.nn.functional.silu(x)
def _sigmoid(x):
    return torch.sigmoid(x)
def _layernorm(x, axis=-1, eps=1e-5):
    m = x.mean(dim=axis, keepdim=True)
    v = x.var(dim=axis, keepdim=True, unbiased=False)
    return (x - m) / torch.sqrt(v + eps)
def _scatter_add(tgt, idx, src, axis=0):
    return tgt.clone().index_add_(axis, idx, src)
def _segment_sum(src, seg, n):
    out = torch.zeros((n,) + src.shape[1:], dtype=src.dtype)
    return out.index_add_(0, seg, src)
def _pad(x, pw):
    flat = tuple(v for pair in reversed(pw) for v in pair)
    return torch.nn.functional.pad(x, flat)

kernel_name = 'sequential_preLN__softmax_full_mha__mixer_channel_mlp__prompt'

def setup_inputs():

    _w = (lambda a: (lambda t: t.to(torch.bfloat16) if t.is_floating_point() else t)(torch.as_tensor(a)))
    def _A_setup():
        B, S, D = 1, 2048, 448
        return {
            "x": _w((lambda *s: torch.randn(*s, dtype=torch.bfloat16) * 0.05)(B, S, D)),
            "wqkv": _w((lambda *s: torch.randn(*s, dtype=torch.bfloat16) * 0.05)(D, 3 * D)),
            "wo": _w((lambda *s: torch.randn(*s, dtype=torch.bfloat16) * 0.05)(D, D)),
        }
    _A_in = _A_setup()

    def _B_setup():
        B, S, D, F = 1, 2048, 448, 1792
        return {
            "x": _w((lambda *s: torch.randn(*s, dtype=torch.bfloat16) * 0.05)(B, S, D)),
            "w1": _w((lambda *s: torch.randn(*s, dtype=torch.bfloat16) * 1.6)(D, F) * (D ** -0.5)),
            "b1": _w((lambda *s: torch.randn(*s, dtype=torch.bfloat16) * 0.8)(F)),
            "w2": _w((lambda *s: torch.randn(*s, dtype=torch.bfloat16) * 0.05)(F, D) * (F ** -0.5)),
            "b2": _w((lambda *s: torch.randn(*s, dtype=torch.bfloat16) * 0.05)(D)),
        }
    _B_in = _B_setup()

    return {
        "A_x": _A_in["x"],
        "A_wqkv": _A_in["wqkv"],
        "A_wo": _A_in["wo"],
        "B_x": _B_in["x"],
        "B_w1": _B_in["w1"],
        "B_b1": _B_in["b1"],
        "B_w2": _B_in["w2"],
        "B_b2": _B_in["b2"],
    }

def reference(A_x, A_wqkv, A_wo, B_x, B_w1, B_b1, B_w2, B_b2):
    def _A_ref(x, wqkv, wo):
        B, S, D = x.shape
        H = 16; Dh = D // H
        qkv = (lambda x, *d: x.permute(*d))((x @ wqkv).reshape(B, S, 3, H, Dh), 2, 0, 3, 1, 4)
        q, k, v = qkv[0], qkv[1], qkv[2]
        scale = Dh ** -0.5
        scores = torch.einsum("bhqd,bhkd->bhqk", q, k) * scale
        p = _softmax(scores, axis=-1)
        o = torch.einsum("bhqk,bhkd->bhqd", p, v)
        return (lambda x, *d: x.permute(*d))(o, 0, 2, 1, 3).reshape(B, S, D) @ wo

    def _B_ref(x, w1, b1, w2, b2):
        y = _layernorm(x, axis=-1)
        h = _gelu(torch.einsum("bsd,df->bsf", y, w1) + b1)
        return torch.einsum("bsf,fd->bsd", h, w2) + b2

    x = A_x
    h = x + _A_ref(_layernorm(x, axis=-1), A_wqkv, A_wo)
    h2 = h + _B_ref(_layernorm(h, axis=-1), B_w1, B_b1, B_w2, B_b2)
    return h2
```

```asm
; @launch grid=(256,1,1) block=(256,1,1) lds=163840
.amdgcn_target "amdgcn-amd-amdhsa--gfx950"
.text
.set CODE_LEN, 35008
.globl sequential_preLN__softmax_full_mha__mixer_channel_mlp__prompt_kernel
.p2align 8
.type sequential_preLN__softmax_full_mha__mixer_channel_mlp__prompt_kernel,@function
sequential_preLN__softmax_full_mha__mixer_channel_mlp__prompt_kernel:
    s_cmp_ge_u32 s2, 256
    s_cbranch_scc1 L_exit
    s_load_dwordx2 s[8:9], s[0:1], 0
    s_load_dwordx2 s[12:13], s[0:1], 8
    s_load_dwordx2 s[40:41], s[0:1], 80
    s_load_dwordx2 s[20:21], s[0:1], 32
    s_load_dwordx2 s[24:25], s[0:1], 40
    s_load_dwordx2 s[16:17], s[0:1], 16
    s_load_dwordx2 s[28:29], s[0:1], 48
    s_load_dwordx2 s[32:33], s[0:1], 56
    s_load_dwordx2 s[36:37], s[0:1], 64
L_pc:
    s_getpc_b64 s[58:59]
    s_lshr_b32 s3, s2, 3
    s_lshl_b32 s3, s3, 11
    v_lshrrev_b32 v3, 4, v0
    v_lshl_add_u32 v3, v3, 7, s3
    v_min_u32 v3, CODE_LEN, v3
    global_load_dword v244, v3, s[58:59]
    v_lshrrev_b32 v2, 6, v0
    v_and_b32 v1, 63, v0
    v_readfirstlane_b32 s44, v2
    s_mov_b32 s10, 0x001c0000
    s_mov_b32 s11, 0x00020000
    s_mov_b32 s14, 0x00126000
    s_mov_b32 s15, 0x00020000
    s_mov_b32 s42, 0x01220000
    s_mov_b32 s43, 0x00020000
    s_mov_b32 s22, 0x00188000
    s_mov_b32 s23, 0x00020000
    s_mov_b32 s26, 0x00000e00
    s_mov_b32 s27, 0x00020000
    s_mov_b32 s18, 0x00062000
    s_mov_b32 s19, 0x00020000
    s_mov_b32 s30, 0x00188000
    s_mov_b32 s31, 0x00020000
    s_mov_b32 s34, 0x00000380
    s_mov_b32 s35, 0x00020000
    s_mov_b32 s38, 0x001c0000
    s_mov_b32 s39, 0x00020000
    s_mov_b32 s45, 0x3f803f80
    s_and_b32 s48, s2, 3
    s_lshl_b32 s48, s48, 2
    s_bfe_u32 s49, s2, 0x20003
    s_add_u32 s46, s48, s49
    s_bfe_u32 s48, s2, 0x10002
    s_lshl_b32 s48, s48, 3
    s_lshr_b32 s50, s2, 5
    s_add_u32 s47, s48, s50
    s_lshl_b32 s55, s46, 2
    s_add_u32 s55, s55, s44
    v_lshlrev_b32 v2, 4, v1
    v_lshlrev_b32 v251, 7, v1
    v_mov_b32 v10, 0
    s_lshl_b32 s54, s44, 14
    s_add_u32 s54, s54, 86016
    s_and_b32 s60, s2, 7
    s_lshl_b32 s60, s60, 2
    s_lshr_b32 s60, 0x31646420, s60
    s_and_b32 s60, s60, 7
    s_xor_b32 s61, s49, s50
    s_and_b32 s61, s61, 1
    v_lshrrev_b32 v3, 3, v1
    v_mul_u32_u24 v5, 896, v3
    v_lshrrev_b32 v4, 4, v1
    v_xor_b32 v4, v4, v1
    v_and_b32 v4, 7, v4
    v_lshl_add_u32 v6, v4, 4, v5
    v_xor_b32 v4, 4, v4
    v_lshl_add_u32 v7, v4, 4, v5
    s_mul_i32 s52, s55, 28672
    v_add_u32 v6, s52, v6
    v_add_u32 v7, s52, v7
    v_add_u32 v7, 6144, v7
    v_add_u32 v34, 12288, v6
    v_add_u32 v35, 12288, v7
    s_lshl_b32 s48, s46, 1
    s_add_u32 s48, s48, s47
    s_sub_u32 s52, s48, 14
    s_add_u32 s48, s47, 7
    s_cmp_ge_u32 s47, 14
    s_cselect_b32 s56, 28, 21
    s_cselect_b32 s53, s52, s48
    s_cselect_b32 s98, s22, s14
    s_lshl_b32 s56, s56, 7
    s_mov_b32 s99, 0x00020000
    s_lshl_b32 s53, s53, 7
    s_lshl_b32 s48, s44, 4
    s_mul_i32 s48, s48, s56
    s_add_u32 s53, s53, s48
    s_lshl_b32 s57, s44, 11
    v_mul_u32_u24 v12, s56, v3
    v_bfe_u32 v3, v1, 4, 1
    v_lshlrev_b32 v3, 2, v3
    v_and_b32 v4, 7, v1
    v_xor_b32 v3, v3, v4
    v_lshl_add_u32 v12, v3, 4, v12
    v_add_u32 v12, s53, v12
    s_lshl_b32 s48, s56, 3
    s_sub_u32 s48, s48, 1024
    v_add_u32 v13, s48, v12
    s_lshr_b32 s56, s56, 1
    s_and_b32 s3, s61, 3
    s_xor_b32 s3, s3, 0
    s_add_u32 s3, s3, s60
    s_sub_u32 s48, s3, 7
    s_cmp_ge_u32 s3, 7
    s_cselect_b32 s3, s48, s3
    s_lshl_b32 s3, s3, 7
    s_and_b32 s4, s61, 3
    s_xor_b32 s4, s4, 1
    s_add_u32 s4, s4, s60
    s_sub_u32 s48, s4, 7
    s_cmp_ge_u32 s4, 7
    s_cselect_b32 s4, s48, s4
    s_lshl_b32 s4, s4, 7
    s_cmp_ge_u32 s47, 14
    s_waitcnt lgkmcnt(0)
    s_cselect_b64 s[96:97], s[20:21], s[12:13]
    s_add_u32 m0, s54, 0
    s_mul_i32 s51, s3, s56
    buffer_load_dwordx4 v6, s[8:11], s3 offen lds
    buffer_load_dwordx4 v7, s[8:11], s3 offen offset:1024 lds
    buffer_load_dwordx4 v34, s[8:11], s3 offen offset:2048 lds
    buffer_load_dwordx4 v35, s[8:11], s3 offen offset:3072 lds
    s_add_u32 m0, s57, 0
    s_nop 0
    buffer_load_dwordx4 v12, s[96:99], s51 offen lds
    buffer_load_dwordx4 v13, s[96:99], s51 offen offset:1024 lds
    s_lshl_b32 s50, s2, 2
    s_add_u32 s50, s50, s44
    s_mul_i32 s48, s50, 1664
    s_mov_b64 exec, 0x1fff
    buffer_load_dword v244, v251, s[20:23], s48 offen
    s_mov_b64 exec, -1
    s_add_u32 s58, s40, 18939904
    s_addc_u32 s59, s41, 0
    s_load_dword s101, s[58:59], 0
    s_and_b32 s5, s61, 3
    s_xor_b32 s5, s5, 2
    s_add_u32 s5, s5, s60
    s_sub_u32 s48, s5, 7
    s_cmp_ge_u32 s5, 7
    s_cselect_b32 s5, s48, s5
    s_lshl_b32 s5, s5, 7
    s_and_b32 s6, s61, 3
    s_xor_b32 s6, s6, 3
    s_add_u32 s6, s6, s60
    s_sub_u32 s48, s6, 7
    s_cmp_ge_u32 s6, 7
    s_cselect_b32 s6, s48, s6
    s_lshl_b32 s6, s6, 7
    s_and_b32 s7, s61, 1
    s_xor_b32 s7, s7, 4
    s_add_u32 s7, s7, s60
    s_sub_u32 s48, s7, 7
    s_cmp_ge_u32 s7, 7
    s_cselect_b32 s7, s48, s7
    s_lshl_b32 s7, s7, 7
    s_and_b32 s62, s61, 1
    s_xor_b32 s62, s62, 5
    s_add_u32 s62, s62, s60
    s_sub_u32 s48, s62, 7
    s_cmp_ge_u32 s62, 7
    s_cselect_b32 s62, s48, s62
    s_lshl_b32 s62, s62, 7
    s_and_b32 s63, s61, 0
    s_xor_b32 s63, s63, 6
    s_add_u32 s63, s63, s60
    s_sub_u32 s48, s63, 7
    s_cmp_ge_u32 s63, 7
    s_cselect_b32 s63, s48, s63
    s_lshl_b32 s63, s63, 7
    s_mul_i32 s48, s47, 7
    s_lshr_b32 s48, s48, 1
    s_lshl_b32 s48, s48, 4
    s_mul_i32 s49, s44, 43008
    s_add_u32 s48, s48, s49
    v_lshrrev_b32 v3, 2, v1
    v_mul_u32_u24 v15, 2624, v3
    v_add3_u32 v15, v15, v2, s48
    v_and_b32 v3, 31, v1
    v_lshlrev_b32 v19, 7, v3
    v_add_u32 v19, s54, v19
    v_lshlrev_b32 v27, 4, v3
    v_add_u32 v27, 151552, v27
    s_lshl_b32 s48, s44, 2
    v_add_u32 v28, s48, v27
    s_lshl_b32 s48, s44, 7
    s_add_u32 s48, s48, 153088
    v_lshl_add_u32 v29, v3, 2, s48
    v_lshrrev_b32 v4, 5, v1
    v_lshl_add_u32 v30, v4, 4, s48
    v_bfe_u32 v3, v1, 1, 3
    v_xor_b32 v3, v3, v4
    v_cmp_lt_u32 vcc, 31, v1
    v_xor_b32 v4, 0, v3
    v_lshl_add_u32 v16, v4, 4, v19
    v_xor_b32 v4, 2, v3
    v_lshl_add_u32 v17, v4, 4, v19
    v_xor_b32 v4, 4, v3
    v_lshl_add_u32 v18, v4, 4, v19
    v_xor_b32 v4, 6, v3
    v_lshl_add_u32 v19, v4, 4, v19
    v_mov_b32 v8, 0
    v_mov_b32 v9, 0
    v_mov_b32 v24, 0
    v_mov_b32 v25, 0
    v_mov_b32 v26, 0
    v_mov_b32 v181, 0
    v_mov_b32 v182, 0
    v_mov_b32 v183, 0
    v_mov_b32 v185, 0
    v_mov_b32 v186, 0
    v_mov_b32 v187, 0
    v_mov_b32 v189, 0
    v_mov_b32 v190, 0
    v_mov_b32 v191, 0
    v_mov_b32 v193, 0
    v_mov_b32 v194, 0
    v_mov_b32 v195, 0
    v_bfe_u32 v3, v1, 2, 2
    v_lshrrev_b32 v4, 5, v1
    v_lshl_add_u32 v4, v4, 3, v3
    v_mul_u32_u24 v14, 64, v4
    v_bfe_u32 v3, v1, 4, 1
    v_lshl_add_u32 v14, v3, 5, v14
    v_and_b32 v3, 1, v1
    v_lshl_add_u32 v14, v3, 4, v14
    v_bfe_u32 v3, v1, 1, 1
    v_lshl_add_u32 v14, v3, 3, v14
    v_add_u32 v14, 57344, v14
    s_lshl_b32 s48, s46, 4
    s_add_u32 s48, s48, s47
    s_lshl_b32 s48, s48, 7
    s_add_u32 s48, s48, 18874368
    s_mov_b64 exec, 1
    buffer_load_dword v244, v10, s[40:43], s48 offen
    s_mov_b64 exec, -1
    s_sub_u32 s48, s47, 7
    s_cmp_lt_u32 s48, 7
    s_cbranch_scc1 L_p1_v
    v_bfe_u32 v3, v1, 2, 2
    v_lshrrev_b32 v4, 5, v1
    v_lshl_add_u32 v4, v4, 3, v3
    v_mul_u32_u24 v20, 128, v4
    v_lshrrev_b32 v3, 1, v3
    v_lshl_add_u32 v20, v3, 6, v20
    v_bfe_u32 v3, v1, 4, 1
    v_lshl_add_u32 v20, v3, 5, v20
    v_and_b32 v3, 1, v1
    v_lshl_add_u32 v20, v3, 4, v20
    v_bfe_u32 v3, v1, 1, 1
    v_lshl_add_u32 v20, v3, 3, v20
    v_xor_b32 v21, 64, v20
    v_add_u32 v22, s57, v20
    v_add_u32 v23, s57, v21
    s_mul_i32 s48, s55, 57472
    s_lshl_b32 s49, s47, 12
    s_add_u32 s48, s48, s49
    s_add_u32 m0, s54, 4096
    s_mul_i32 s51, s4, s56
    buffer_load_dwordx4 v6, s[8:11], s4 offen lds
    buffer_load_dwordx4 v7, s[8:11], s4 offen offset:1024 lds
    buffer_load_dwordx4 v34, s[8:11], s4 offen offset:2048 lds
    buffer_load_dwordx4 v35, s[8:11], s4 offen offset:3072 lds
    s_add_u32 m0, s57, 8192
    s_nop 0
    buffer_load_dwordx4 v12, s[96:99], s51 offen lds
    buffer_load_dwordx4 v13, s[96:99], s51 offen offset:1024 lds
    s_waitcnt lgkmcnt(0)
    s_waitcnt vmcnt(8)
    s_barrier
    ds_read_b128 v[36:39], v16 offset:0
    ds_read_b64_tr_b16 v[148:149], v20 offset:0
    ds_read_b64_tr_b16 v[150:151], v20 offset:512
    ds_read_b64_tr_b16 v[152:153], v21 offset:0
    ds_read_b64_tr_b16 v[154:155], v21 offset:512
    ds_read_b128 v[40:43], v17 offset:0
    ds_read_b64_tr_b16 v[156:157], v20 offset:2048
    ds_read_b64_tr_b16 v[158:159], v20 offset:2560
    ds_read_b64_tr_b16 v[160:161], v21 offset:2048
    ds_read_b64_tr_b16 v[162:163], v21 offset:2560
    ds_read_b128 v[44:47], v18 offset:0
    ds_read_b128 v[48:51], v19 offset:0
    s_waitcnt lgkmcnt(9)
    v_mfma_f32_32x32x16_bf16 v[212:227], v[148:151], v[36:39], 0
    ds_read_b64_tr_b16 v[172:173], v22 offset:0
    ds_read_b64_tr_b16 v[174:175], v22 offset:512
    ds_read_b64_tr_b16 v[164:165], v20 offset:4096
    ds_read_b64_tr_b16 v[166:167], v20 offset:4608
    ds_read_b64_tr_b16 v[168:169], v21 offset:4096
    ds_read_b64_tr_b16 v[170:171], v21 offset:4608
    s_add_u32 m0, s54, 8192
    s_mul_i32 s51, s5, s56
    buffer_load_dwordx4 v6, s[8:11], s5 offen lds
    s_waitcnt lgkmcnt(13)
    v_mfma_f32_32x32x16_bf16 v[228:243], v[152:155], v[36:39], 0
    buffer_load_dwordx4 v7, s[8:11], s5 offen offset:1024 lds
    buffer_load_dwordx4 v34, s[8:11], s5 offen offset:2048 lds
    buffer_load_dwordx4 v35, s[8:11], s5 offen offset:3072 lds
    s_waitcnt lgkmcnt(10)
    v_mfma_f32_32x32x16_bf16 v[212:227], v[156:159], v[40:43], v[212:227]
    ds_read_b64_tr_b16 v[176:177], v23 offset:0
    ds_read_b64_tr_b16 v[178:179], v23 offset:512
    ds_read_b64_tr_b16 v[148:149], v20 offset:6144
    ds_read_b64_tr_b16 v[150:151], v20 offset:6656
    ds_read_b64_tr_b16 v[152:153], v21 offset:6144
    ds_read_b64_tr_b16 v[154:155], v21 offset:6656
    s_add_u32 m0, s57, 16384
    s_nop 0
    buffer_load_dwordx4 v12, s[96:99], s51 offen lds
    s_waitcnt lgkmcnt(14)
    v_mfma_f32_32x32x16_bf16 v[228:243], v[160:163], v[40:43], v[228:243]
    buffer_load_dwordx4 v13, s[96:99], s51 offen offset:1024 lds
    s_lshr_b32 m0, s57, 1
    s_mul_i32 s51, s3, 1344
    s_add_u32 m0, m0, 57344
    s_nop 0
    buffer_load_dwordx4 v15, s[12:15], s51 offen lds
    v_dot2c_f32_bf16 v8, s45, v36
    v_dot2c_f32_bf16 v9, v36, v36
    v_dot2c_f32_bf16 v8, s45, v37
    v_dot2c_f32_bf16 v9, v37, v37
    v_dot2c_f32_bf16 v8, s45, v38
    v_dot2c_f32_bf16 v9, v38, v38
    v_dot2c_f32_bf16 v8, s45, v39
    v_dot2c_f32_bf16 v9, v39, v39
    v_dot2c_f32_bf16 v8, s45, v40
    v_dot2c_f32_bf16 v9, v40, v40
    v_dot2c_f32_bf16 v8, s45, v41
    v_dot2c_f32_bf16 v9, v41, v41
    v_dot2c_f32_bf16 v8, s45, v42
    v_dot2c_f32_bf16 v9, v42, v42
    v_dot2c_f32_bf16 v8, s45, v43
    v_dot2c_f32_bf16 v9, v43, v43
    s_waitcnt lgkmcnt(13)
    v_dot2c_f32_bf16 v8, s45, v44
    v_dot2c_f32_bf16 v9, v44, v44
    v_dot2c_f32_bf16 v8, s45, v45
    v_dot2c_f32_bf16 v9, v45, v45
    v_dot2c_f32_bf16 v8, s45, v46
    v_dot2c_f32_bf16 v9, v46, v46
    v_dot2c_f32_bf16 v8, s45, v47
    v_dot2c_f32_bf16 v9, v47, v47
    s_waitcnt lgkmcnt(12)
    v_dot2c_f32_bf16 v8, s45, v48
    v_dot2c_f32_bf16 v9, v48, v48
    v_dot2c_f32_bf16 v8, s45, v49
    v_dot2c_f32_bf16 v9, v49, v49
    v_dot2c_f32_bf16 v8, s45, v50
    v_dot2c_f32_bf16 v9, v50, v50
    v_dot2c_f32_bf16 v8, s45, v51
    v_dot2c_f32_bf16 v9, v51, v51
    s_waitcnt lgkmcnt(11)
    v_dot2c_f32_bf16 v24, s45, v172
    v_dot2c_f32_bf16 v24, s45, v173
    s_waitcnt lgkmcnt(10)
    v_dot2c_f32_bf16 v24, s45, v174
    v_dot2c_f32_bf16 v24, s45, v175
    s_waitcnt lgkmcnt(5)
    v_dot2c_f32_bf16 v25, s45, v176
    v_dot2c_f32_bf16 v25, s45, v177
    s_waitcnt lgkmcnt(4)
    v_dot2c_f32_bf16 v25, s45, v178
    v_dot2c_f32_bf16 v25, s45, v179
    s_waitcnt vmcnt(7)
    s_barrier
    v_mfma_f32_32x32x16_bf16 v[212:227], v[164:167], v[44:47], v[212:227]
    ds_read_b128 v[52:55], v16 offset:4096
    ds_read_b64_tr_b16 v[156:157], v20 offset:8192
    ds_read_b64_tr_b16 v[158:159], v20 offset:8704
    ds_read_b64_tr_b16 v[160:161], v21 offset:8192
    ds_read_b64_tr_b16 v[162:163], v21 offset:8704
    v_mfma_f32_32x32x16_bf16 v[228:243], v[168:171], v[44:47], v[228:243]
    s_add_u32 m0, s54, 12288
    s_mul_i32 s51, s6, s56
    buffer_load_dwordx4 v6, s[8:11], s6 offen lds
    buffer_load_dwordx4 v7, s[8:11], s6 offen offset:1024 lds
    s_waitcnt lgkmcnt(7)
    v_mfma_f32_32x32x16_bf16 v[212:227], v[148:151], v[48:51], v[212:227]
    ds_read_b128 v[56:59], v17 offset:4096
    ds_read_b64_tr_b16 v[164:165], v20 offset:10240
    ds_read_b64_tr_b16 v[166:167], v20 offset:10752
    ds_read_b64_tr_b16 v[168:169], v21 offset:10240
    s_waitcnt lgkmcnt(9)
    v_mfma_f32_32x32x16_bf16 v[228:243], v[152:155], v[48:51], v[228:243]
    ds_read_b64_tr_b16 v[170:171], v21 offset:10752
    buffer_load_dwordx4 v34, s[8:11], s6 offen offset:2048 lds
    buffer_load_dwordx4 v35, s[8:11], s6 offen offset:3072 lds
    s_waitcnt lgkmcnt(7)
    v_mfma_f32_32x32x16_bf16 v[212:227], v[156:159], v[52:55], v[212:227]
    ds_read_b128 v[60:63], v18 offset:4096
    ds_read_b128 v[64:67], v19 offset:4096
    ds_read_b64_tr_b16 v[172:173], v22 offset:8192
    ds_read_b64_tr_b16 v[174:175], v22 offset:8704
    ds_read_b64_tr_b16 v[148:149], v20 offset:12288
    s_waitcnt lgkmcnt(10)
    v_mfma_f32_32x32x16_bf16 v[228:243], v[160:163], v[52:55], v[228:243]
    ds_read_b64_tr_b16 v[150:151], v20 offset:12800
    ds_read_b64_tr_b16 v[152:153], v21 offset:12288
    ds_read_b64_tr_b16 v[154:155], v21 offset:12800
    s_add_u32 m0, s57, 24576
    s_nop 0
    buffer_load_dwordx4 v12, s[96:99], s51 offen lds
    s_waitcnt lgkmcnt(10)
    v_mfma_f32_32x32x16_bf16 v[212:227], v[164:167], v[56:59], v[212:227]
    ds_read_b64_tr_b16 v[176:177], v23 offset:8192
    ds_read_b64_tr_b16 v[178:179], v23 offset:8704
    ds_read_b64_tr_b16 v[156:157], v20 offset:14336
    ds_read_b64_tr_b16 v[158:159], v20 offset:14848
    ds_read_b64_tr_b16 v[160:161], v21 offset:14336
    ds_read_b64_tr_b16 v[162:163], v21 offset:14848
    s_waitcnt lgkmcnt(14)
    v_mfma_f32_32x32x16_bf16 v[228:243], v[168:171], v[56:59], v[228:243]
    buffer_load_dwordx4 v13, s[96:99], s51 offen offset:1024 lds
    s_lshr_b32 m0, s57, 1
    s_mul_i32 s51, s4, 1344
    s_add_u32 m0, m0, 61440
    s_nop 0
    buffer_load_dwordx4 v15, s[12:15], s51 offen lds
    v_dot2c_f32_bf16 v8, s45, v52
    v_dot2c_f32_bf16 v9, v52, v52
    v_dot2c_f32_bf16 v8, s45, v53
    v_dot2c_f32_bf16 v9, v53, v53
    v_dot2c_f32_bf16 v8, s45, v54
    v_dot2c_f32_bf16 v9, v54, v54
    v_dot2c_f32_bf16 v8, s45, v55
    v_dot2c_f32_bf16 v9, v55, v55
    v_dot2c_f32_bf16 v8, s45, v56
    v_dot2c_f32_bf16 v9, v56, v56
    v_dot2c_f32_bf16 v8, s45, v57
    v_dot2c_f32_bf16 v9, v57, v57
    v_dot2c_f32_bf16 v8, s45, v58
    v_dot2c_f32_bf16 v9, v58, v58
    v_dot2c_f32_bf16 v8, s45, v59
    v_dot2c_f32_bf16 v9, v59, v59
    s_waitcnt lgkmcnt(13)
    v_dot2c_f32_bf16 v8, s45, v60
    v_dot2c_f32_bf16 v9, v60, v60
    v_dot2c_f32_bf16 v8, s45, v61
    v_dot2c_f32_bf16 v9, v61, v61
    v_dot2c_f32_bf16 v8, s45, v62
    v_dot2c_f32_bf16 v9, v62, v62
    v_dot2c_f32_bf16 v8, s45, v63
    v_dot2c_f32_bf16 v9, v63, v63
    s_waitcnt lgkmcnt(12)
    v_dot2c_f32_bf16 v8, s45, v64
    v_dot2c_f32_bf16 v9, v64, v64
    v_dot2c_f32_bf16 v8, s45, v65
    v_dot2c_f32_bf16 v9, v65, v65
    v_dot2c_f32_bf16 v8, s45, v66
    v_dot2c_f32_bf16 v9, v66, v66
    v_dot2c_f32_bf16 v8, s45, v67
    v_dot2c_f32_bf16 v9, v67, v67
    s_waitcnt lgkmcnt(11)
    v_dot2c_f32_bf16 v24, s45, v172
    v_dot2c_f32_bf16 v24, s45, v173
    s_waitcnt lgkmcnt(10)
    v_dot2c_f32_bf16 v24, s45, v174
    v_dot2c_f32_bf16 v24, s45, v175
    s_waitcnt lgkmcnt(5)
    v_dot2c_f32_bf16 v25, s45, v176
    v_dot2c_f32_bf16 v25, s45, v177
    s_waitcnt lgkmcnt(4)
    v_dot2c_f32_bf16 v25, s45, v178
    v_dot2c_f32_bf16 v25, s45, v179
    s_waitcnt vmcnt(8)
    s_barrier
    v_mfma_f32_32x32x16_bf16 v[212:227], v[148:151], v[60:63], v[212:227]
    ds_read_b128 v[68:71], v16 offset:8192
    ds_read_b64_tr_b16 v[164:165], v20 offset:16384
    ds_read_b64_tr_b16 v[166:167], v20 offset:16896
    ds_read_b64_tr_b16 v[168:169], v21 offset:16384
    ds_read_b64_tr_b16 v[170:171], v21 offset:16896
    v_mfma_f32_32x32x16_bf16 v[228:243], v[152:155], v[60:63], v[228:243]
    s_add_u32 m0, s54, 0
    s_mul_i32 s51, s7, s56
    buffer_load_dwordx4 v6, s[8:11], s7 offen lds
    buffer_load_dwordx4 v7, s[8:11], s7 offen offset:1024 lds
    s_waitcnt lgkmcnt(7)
    v_mfma_f32_32x32x16_bf16 v[212:227], v[156:159], v[64:67], v[212:227]
    ds_read_b128 v[72:75], v17 offset:8192
    ds_read_b64_tr_b16 v[148:149], v20 offset:18432
    ds_read_b64_tr_b16 v[150:151], v20 offset:18944
    ds_read_b64_tr_b16 v[152:153], v21 offset:18432
    s_waitcnt lgkmcnt(9)
    v_mfma_f32_32x32x16_bf16 v[228:243], v[160:163], v[64:67], v[228:243]
    ds_read_b64_tr_b16 v[154:155], v21 offset:18944
    buffer_load_dwordx4 v34, s[8:11], s7 offen offset:2048 lds
    buffer_load_dwordx4 v35, s[8:11], s7 offen offset:3072 lds
    s_waitcnt lgkmcnt(7)
    v_mfma_f32_32x32x16_bf16 v[212:227], v[164:167], v[68:71], v[212:227]
    ds_read_b128 v[76:79], v18 offset:8192
    ds_read_b128 v[80:83], v19 offset:8192
    ds_read_b64_tr_b16 v[172:173], v22 offset:16384
    ds_read_b64_tr_b16 v[174:175], v22 offset:16896
    ds_read_b64_tr_b16 v[156:157], v20 offset:20480
    s_waitcnt lgkmcnt(10)
    v_mfma_f32_32x32x16_bf16 v[228:243], v[168:171], v[68:71], v[228:243]
    ds_read_b64_tr_b16 v[158:159], v20 offset:20992
    ds_read_b64_tr_b16 v[160:161], v21 offset:20480
    ds_read_b64_tr_b16 v[162:163], v21 offset:20992
    s_add_u32 m0, s57, 32768
    s_nop 0
    buffer_load_dwordx4 v12, s[96:99], s51 offen lds
    s_waitcnt lgkmcnt(10)
    v_mfma_f32_32x32x16_bf16 v[212:227], v[148:151], v[72:75], v[212:227]
    ds_read_b64_tr_b16 v[176:177], v23 offset:16384
    ds_read_b64_tr_b16 v[178:179], v23 offset:16896
    ds_read_b64_tr_b16 v[164:165], v20 offset:22528
    ds_read_b64_tr_b16 v[166:167], v20 offset:23040
    ds_read_b64_tr_b16 v[168:169], v21 offset:22528
    ds_read_b64_tr_b16 v[170:171], v21 offset:23040
    s_waitcnt lgkmcnt(14)
    v_mfma_f32_32x32x16_bf16 v[228:243], v[152:155], v[72:75], v[228:243]
    buffer_load_dwordx4 v13, s[96:99], s51 offen offset:1024 lds
    s_lshr_b32 m0, s57, 1
    s_mul_i32 s51, s5, 1344
    s_add_u32 m0, m0, 65536
    s_nop 0
    buffer_load_dwordx4 v15, s[12:15], s51 offen lds
    v_dot2c_f32_bf16 v8, s45, v68
    v_dot2c_f32_bf16 v9, v68, v68
    v_dot2c_f32_bf16 v8, s45, v69
    v_dot2c_f32_bf16 v9, v69, v69
    v_dot2c_f32_bf16 v8, s45, v70
    v_dot2c_f32_bf16 v9, v70, v70
    v_dot2c_f32_bf16 v8, s45, v71
    v_dot2c_f32_bf16 v9, v71, v71
    v_dot2c_f32_bf16 v8, s45, v72
    v_dot2c_f32_bf16 v9, v72, v72
    v_dot2c_f32_bf16 v8, s45, v73
    v_dot2c_f32_bf16 v9, v73, v73
    v_dot2c_f32_bf16 v8, s45, v74
    v_dot2c_f32_bf16 v9, v74, v74
    v_dot2c_f32_bf16 v8, s45, v75
    v_dot2c_f32_bf16 v9, v75, v75
    s_waitcnt lgkmcnt(13)
    v_dot2c_f32_bf16 v8, s45, v76
    v_dot2c_f32_bf16 v9, v76, v76
    v_dot2c_f32_bf16 v8, s45, v77
    v_dot2c_f32_bf16 v9, v77, v77
    v_dot2c_f32_bf16 v8, s45, v78
    v_dot2c_f32_bf16 v9, v78, v78
    v_dot2c_f32_bf16 v8, s45, v79
    v_dot2c_f32_bf16 v9, v79, v79
    s_waitcnt lgkmcnt(12)
    v_dot2c_f32_bf16 v8, s45, v80
    v_dot2c_f32_bf16 v9, v80, v80
    v_dot2c_f32_bf16 v8, s45, v81
    v_dot2c_f32_bf16 v9, v81, v81
    v_dot2c_f32_bf16 v8, s45, v82
    v_dot2c_f32_bf16 v9, v82, v82
    v_dot2c_f32_bf16 v8, s45, v83
    v_dot2c_f32_bf16 v9, v83, v83
    s_waitcnt lgkmcnt(11)
    v_dot2c_f32_bf16 v24, s45, v172
    v_dot2c_f32_bf16 v24, s45, v173
    s_waitcnt lgkmcnt(10)
    v_dot2c_f32_bf16 v24, s45, v174
    v_dot2c_f32_bf16 v24, s45, v175
    s_waitcnt lgkmcnt(5)
    v_dot2c_f32_bf16 v25, s45, v176
    v_dot2c_f32_bf16 v25, s45, v177
    s_waitcnt lgkmcnt(4)
    v_dot2c_f32_bf16 v25, s45, v178
    v_dot2c_f32_bf16 v25, s45, v179
    s_waitcnt vmcnt(8)
    s_barrier
    v_mfma_f32_32x32x16_bf16 v[212:227], v[156:159], v[76:79], v[212:227]
    ds_read_b128 v[84:87], v16 offset:12288
    ds_read_b64_tr_b16 v[148:149], v20 offset:24576
    ds_read_b64_tr_b16 v[150:151], v20 offset:25088
    ds_read_b64_tr_b16 v[152:153], v21 offset:24576
    ds_read_b64_tr_b16 v[154:155], v21 offset:25088
    v_mfma_f32_32x32x16_bf16 v[228:243], v[160:163], v[76:79], v[228:243]
    s_add_u32 m0, s54, 4096
    s_mul_i32 s51, s62, s56
    buffer_load_dwordx4 v6, s[8:11], s62 offen lds
    buffer_load_dwordx4 v7, s[8:11], s62 offen offset:1024 lds
    s_waitcnt lgkmcnt(7)
    v_mfma_f32_32x32x16_bf16 v[212:227], v[164:167], v[80:83], v[212:227]
    ds_read_b128 v[88:91], v17 offset:12288
    ds_read_b64_tr_b16 v[156:157], v20 offset:26624
    ds_read_b64_tr_b16 v[158:159], v20 offset:27136
    ds_read_b64_tr_b16 v[160:161], v21 offset:26624
    s_waitcnt lgkmcnt(9)
    v_mfma_f32_32x32x16_bf16 v[228:243], v[168:171], v[80:83], v[228:243]
    ds_read_b64_tr_b16 v[162:163], v21 offset:27136
    buffer_load_dwordx4 v34, s[8:11], s62 offen offset:2048 lds
    buffer_load_dwordx4 v35, s[8:11], s62 offen offset:3072 lds
    s_waitcnt lgkmcnt(7)
    v_mfma_f32_32x32x16_bf16 v[212:227], v[148:151], v[84:87], v[212:227]
    ds_read_b128 v[92:95], v18 offset:12288
    ds_read_b128 v[96:99], v19 offset:12288
    ds_read_b64_tr_b16 v[172:173], v22 offset:24576
    ds_read_b64_tr_b16 v[174:175], v22 offset:25088
    ds_read_b64_tr_b16 v[164:165], v20 offset:28672
    s_waitcnt lgkmcnt(10)
    v_mfma_f32_32x32x16_bf16 v[228:243], v[152:155], v[84:87], v[228:243]
    ds_read_b64_tr_b16 v[166:167], v20 offset:29184
    ds_read_b64_tr_b16 v[168:169], v21 offset:28672
    ds_read_b64_tr_b16 v[170:171], v21 offset:29184
    s_add_u32 m0, s57, 40960
    s_nop 0
    buffer_load_dwordx4 v12, s[96:99], s51 offen lds
    s_waitcnt lgkmcnt(10)
    v_mfma_f32_32x32x16_bf16 v[212:227], v[156:159], v[88:91], v[212:227]
    ds_read_b64_tr_b16 v[176:177], v23 offset:24576
    ds_read_b64_tr_b16 v[178:179], v23 offset:25088
    ds_read_b64_tr_b16 v[148:149], v20 offset:30720
    ds_read_b64_tr_b16 v[150:151], v20 offset:31232
    ds_read_b64_tr_b16 v[152:153], v21 offset:30720
    ds_read_b64_tr_b16 v[154:155], v21 offset:31232
    s_waitcnt lgkmcnt(14)
    v_mfma_f32_32x32x16_bf16 v[228:243], v[160:163], v[88:91], v[228:243]
    buffer_load_dwordx4 v13, s[96:99], s51 offen offset:1024 lds
    s_lshr_b32 m0, s57, 1
    s_mul_i32 s51, s6, 1344
    s_add_u32 m0, m0, 69632
    s_nop 0
    buffer_load_dwordx4 v15, s[12:15], s51 offen lds
    v_dot2c_f32_bf16 v8, s45, v84
    v_dot2c_f32_bf16 v9, v84, v84
    v_dot2c_f32_bf16 v8, s45, v85
    v_dot2c_f32_bf16 v9, v85, v85
    v_dot2c_f32_bf16 v8, s45, v86
    v_dot2c_f32_bf16 v9, v86, v86
    v_dot2c_f32_bf16 v8, s45, v87
    v_dot2c_f32_bf16 v9, v87, v87
    v_dot2c_f32_bf16 v8, s45, v88
    v_dot2c_f32_bf16 v9, v88, v88
    v_dot2c_f32_bf16 v8, s45, v89
    v_dot2c_f32_bf16 v9, v89, v89
    v_dot2c_f32_bf16 v8, s45, v90
    v_dot2c_f32_bf16 v9, v90, v90
    v_dot2c_f32_bf16 v8, s45, v91
    v_dot2c_f32_bf16 v9, v91, v91
    s_waitcnt lgkmcnt(13)
    v_dot2c_f32_bf16 v8, s45, v92
    v_dot2c_f32_bf16 v9, v92, v92
    v_dot2c_f32_bf16 v8, s45, v93
    v_dot2c_f32_bf16 v9, v93, v93
    v_dot2c_f32_bf16 v8, s45, v94
    v_dot2c_f32_bf16 v9, v94, v94
    v_dot2c_f32_bf16 v8, s45, v95
    v_dot2c_f32_bf16 v9, v95, v95
    s_waitcnt lgkmcnt(12)
    v_dot2c_f32_bf16 v8, s45, v96
    v_dot2c_f32_bf16 v9, v96, v96
    v_dot2c_f32_bf16 v8, s45, v97
    v_dot2c_f32_bf16 v9, v97, v97
    v_dot2c_f32_bf16 v8, s45, v98
    v_dot2c_f32_bf16 v9, v98, v98
    v_dot2c_f32_bf16 v8, s45, v99
    v_dot2c_f32_bf16 v9, v99, v99
    s_waitcnt lgkmcnt(11)
    v_dot2c_f32_bf16 v24, s45, v172
    v_dot2c_f32_bf16 v24, s45, v173
    s_waitcnt lgkmcnt(10)
    v_dot2c_f32_bf16 v24, s45, v174
    v_dot2c_f32_bf16 v24, s45, v175
    s_waitcnt lgkmcnt(5)
    v_dot2c_f32_bf16 v25, s45, v176
    v_dot2c_f32_bf16 v25, s45, v177
    s_waitcnt lgkmcnt(4)
    v_dot2c_f32_bf16 v25, s45, v178
    v_dot2c_f32_bf16 v25, s45, v179
    s_waitcnt vmcnt(8)
    s_barrier
    v_mfma_f32_32x32x16_bf16 v[212:227], v[164:167], v[92:95], v[212:227]
    ds_read_b128 v[100:103], v16 offset:0
    ds_read_b64_tr_b16 v[156:157], v20 offset:32768
    ds_read_b64_tr_b16 v[158:159], v20 offset:33280
    ds_read_b64_tr_b16 v[160:161], v21 offset:32768
    ds_read_b64_tr_b16 v[162:163], v21 offset:33280
    v_mfma_f32_32x32x16_bf16 v[228:243], v[168:171], v[92:95], v[228:243]
    s_add_u32 m0, s54, 8192
    s_mul_i32 s51, s63, s56
    buffer_load_dwordx4 v6, s[8:11], s63 offen lds
    buffer_load_dwordx4 v7, s[8:11], s63 offen offset:1024 lds
    s_waitcnt lgkmcnt(7)
    v_mfma_f32_32x32x16_bf16 v[212:227], v[148:151], v[96:99], v[212:227]
    ds_read_b128 v[104:107], v17 offset:0
    ds_read_b64_tr_b16 v[164:165], v20 offset:34816
    ds_read_b64_tr_b16 v[166:167], v20 offset:35328
    ds_read_b64_tr_b16 v[168:169], v21 offset:34816
    s_waitcnt lgkmcnt(9)
    v_mfma_f32_32x32x16_bf16 v[228:243], v[152:155], v[96:99], v[228:243]
    ds_read_b64_tr_b16 v[170:171], v21 offset:35328
    buffer_load_dwordx4 v34, s[8:11], s63 offen offset:2048 lds
    buffer_load_dwordx4 v35, s[8:11], s63 offen offset:3072 lds
    s_waitcnt lgkmcnt(7)
    v_mfma_f32_32x32x16_bf16 v[212:227], v[156:159], v[100:103], v[212:227]
    ds_read_b128 v[108:111], v18 offset:0
    ds_read_b128 v[112:115], v19 offset:0
    ds_read_b64_tr_b16 v[172:173], v22 offset:32768
    ds_read_b64_tr_b16 v[174:175], v22 offset:33280
    ds_read_b64_tr_b16 v[148:149], v20 offset:36864
    s_waitcnt lgkmcnt(10)
    v_mfma_f32_32x32x16_bf16 v[228:243], v[160:163], v[100:103], v[228:243]
    ds_read_b64_tr_b16 v[150:151], v20 offset:37376
    ds_read_b64_tr_b16 v[152:153], v21 offset:36864
    ds_read_b64_tr_b16 v[154:155], v21 offset:37376
    s_add_u32 m0, s57, 49152
    s_nop 0
    buffer_load_dwordx4 v12, s[96:99], s51 offen lds
    s_waitcnt lgkmcnt(10)
    v_mfma_f32_32x32x16_bf16 v[212:227], v[164:167], v[104:107], v[212:227]
    ds_read_b64_tr_b16 v[176:177], v23 offset:32768
    ds_read_b64_tr_b16 v[178:179], v23 offset:33280
    ds_read_b64_tr_b16 v[156:157], v20 offset:38912
    ds_read_b64_tr_b16 v[158:159], v20 offset:39424
    ds_read_b64_tr_b16 v[160:161], v21 offset:38912
    ds_read_b64_tr_b16 v[162:163], v21 offset:39424
    s_waitcnt lgkmcnt(14)
    v_mfma_f32_32x32x16_bf16 v[228:243], v[168:171], v[104:107], v[228:243]
    buffer_load_dwordx4 v13, s[96:99], s51 offen offset:1024 lds
    s_lshr_b32 m0, s57, 1
    s_mul_i32 s51, s7, 1344
    s_add_u32 m0, m0, 73728
    s_nop 0
    buffer_load_dwordx4 v15, s[12:15], s51 offen lds
    v_dot2c_f32_bf16 v8, s45, v100
    v_dot2c_f32_bf16 v9, v100, v100
    v_dot2c_f32_bf16 v8, s45, v101
    v_dot2c_f32_bf16 v9, v101, v101
    v_dot2c_f32_bf16 v8, s45, v102
    v_dot2c_f32_bf16 v9, v102, v102
    v_dot2c_f32_bf16 v8, s45, v103
    v_dot2c_f32_bf16 v9, v103, v103
    v_dot2c_f32_bf16 v8, s45, v104
    v_dot2c_f32_bf16 v9, v104, v104
    v_dot2c_f32_bf16 v8, s45, v105
    v_dot2c_f32_bf16 v9, v105, v105
    v_dot2c_f32_bf16 v8, s45, v106
    v_dot2c_f32_bf16 v9, v106, v106
    v_dot2c_f32_bf16 v8, s45, v107
    v_dot2c_f32_bf16 v9, v107, v107
    s_waitcnt lgkmcnt(13)
    v_dot2c_f32_bf16 v8, s45, v108
    v_dot2c_f32_bf16 v9, v108, v108
    v_dot2c_f32_bf16 v8, s45, v109
    v_dot2c_f32_bf16 v9, v109, v109
    v_dot2c_f32_bf16 v8, s45, v110
    v_dot2c_f32_bf16 v9, v110, v110
    v_dot2c_f32_bf16 v8, s45, v111
    v_dot2c_f32_bf16 v9, v111, v111
    s_waitcnt lgkmcnt(12)
    v_dot2c_f32_bf16 v8, s45, v112
    v_dot2c_f32_bf16 v9, v112, v112
    v_dot2c_f32_bf16 v8, s45, v113
    v_dot2c_f32_bf16 v9, v113, v113
    v_dot2c_f32_bf16 v8, s45, v114
    v_dot2c_f32_bf16 v9, v114, v114
    v_dot2c_f32_bf16 v8, s45, v115
    v_dot2c_f32_bf16 v9, v115, v115
    s_waitcnt lgkmcnt(11)
    v_dot2c_f32_bf16 v24, s45, v172
    v_dot2c_f32_bf16 v24, s45, v173
    s_waitcnt lgkmcnt(10)
    v_dot2c_f32_bf16 v24, s45, v174
    v_dot2c_f32_bf16 v24, s45, v175
    s_waitcnt lgkmcnt(5)
    v_dot2c_f32_bf16 v25, s45, v176
    v_dot2c_f32_bf16 v25, s45, v177
    s_waitcnt lgkmcnt(4)
    v_dot2c_f32_bf16 v25, s45, v178
    v_dot2c_f32_bf16 v25, s45, v179
    s_waitcnt vmcnt(8)
    s_barrier
    v_mfma_f32_32x32x16_bf16 v[212:227], v[148:151], v[108:111], v[212:227]
    ds_read_b128 v[116:119], v16 offset:4096
    ds_read_b64_tr_b16 v[164:165], v20 offset:40960
    ds_read_b64_tr_b16 v[166:167], v20 offset:41472
    ds_read_b64_tr_b16 v[168:169], v21 offset:40960
    ds_read_b64_tr_b16 v[170:171], v21 offset:41472
    v_mfma_f32_32x32x16_bf16 v[228:243], v[152:155], v[108:111], v[228:243]
    s_lshl_b32 s51, s2, 2
    s_add_u32 s51, s51, s44
    s_lshl_b32 s51, s51, 9
    s_mov_b64 exec, 0xf
    buffer_load_dword v244, v251, s[16:19], s51 offen
    s_lshl_b32 s51, s51, 2
    s_mov_b64 exec, 0xffff
    buffer_load_dword v244, v251, s[28:31], s51 offen
    s_mov_b64 exec, -1
    s_lshr_b32 m0, s57, 1
    s_mul_i32 s51, s62, 1344
    s_add_u32 m0, m0, 77824
    s_nop 0
    buffer_load_dwordx4 v15, s[12:15], s51 offen lds
    s_waitcnt lgkmcnt(7)
    v_mfma_f32_32x32x16_bf16 v[212:227], v[156:159], v[112:115], v[212:227]
    ds_read_b128 v[120:123], v17 offset:4096
    ds_read_b64_tr_b16 v[148:149], v20 offset:43008
    s_waitcnt lgkmcnt(7)
    v_mfma_f32_32x32x16_bf16 v[228:243], v[160:163], v[112:115], v[228:243]
    ds_read_b64_tr_b16 v[150:151], v20 offset:43520
    ds_read_b64_tr_b16 v[152:153], v21 offset:43008
    ds_read_b64_tr_b16 v[154:155], v21 offset:43520
    s_waitcnt lgkmcnt(7)
    v_mfma_f32_32x32x16_bf16 v[212:227], v[164:167], v[116:119], v[212:227]
    ds_read_b128 v[124:127], v18 offset:4096
    ds_read_b128 v[128:131], v19 offset:4096
    ds_read_b64_tr_b16 v[172:173], v22 offset:40960
    s_waitcnt lgkmcnt(8)
    v_mfma_f32_32x32x16_bf16 v[228:243], v[168:171], v[116:119], v[228:243]
    ds_read_b64_tr_b16 v[174:175], v22 offset:41472
    ds_read_b64_tr_b16 v[156:157], v20 offset:45056
    ds_read_b64_tr_b16 v[158:159], v20 offset:45568
    ds_read_b64_tr_b16 v[160:161], v21 offset:45056
    ds_read_b64_tr_b16 v[162:163], v21 offset:45568
    s_waitcnt lgkmcnt(10)
    v_mfma_f32_32x32x16_bf16 v[212:227], v[148:151], v[120:123], v[212:227]
    ds_read_b64_tr_b16 v[176:177], v23 offset:40960
    ds_read_b64_tr_b16 v[178:179], v23 offset:41472
    ds_read_b64_tr_b16 v[164:165], v20 offset:47104
    s_waitcnt lgkmcnt(11)
    v_mfma_f32_32x32x16_bf16 v[228:243], v[152:155], v[120:123], v[228:243]
    ds_read_b64_tr_b16 v[166:167], v20 offset:47616
    ds_read_b64_tr_b16 v[168:169], v21 offset:47104
    ds_read_b64_tr_b16 v[170:171], v21 offset:47616
    v_dot2c_f32_bf16 v8, s45, v116
    v_dot2c_f32_bf16 v9, v116, v116
    v_dot2c_f32_bf16 v8, s45, v117
    v_dot2c_f32_bf16 v9, v117, v117
    v_dot2c_f32_bf16 v8, s45, v118
    v_dot2c_f32_bf16 v9, v118, v118
    v_dot2c_f32_bf16 v8, s45, v119
    v_dot2c_f32_bf16 v9, v119, v119
    v_dot2c_f32_bf16 v8, s45, v120
    v_dot2c_f32_bf16 v9, v120, v120
    v_dot2c_f32_bf16 v8, s45, v121
    v_dot2c_f32_bf16 v9, v121, v121
    v_dot2c_f32_bf16 v8, s45, v122
    v_dot2c_f32_bf16 v9, v122, v122
    v_dot2c_f32_bf16 v8, s45, v123
    v_dot2c_f32_bf16 v9, v123, v123
    s_waitcnt lgkmcnt(13)
    v_dot2c_f32_bf16 v8, s45, v124
    v_dot2c_f32_bf16 v9, v124, v124
    v_dot2c_f32_bf16 v8, s45, v125
    v_dot2c_f32_bf16 v9, v125, v125
    v_dot2c_f32_bf16 v8, s45, v126
    v_dot2c_f32_bf16 v9, v126, v126
    v_dot2c_f32_bf16 v8, s45, v127
    v_dot2c_f32_bf16 v9, v127, v127
    s_waitcnt lgkmcnt(12)
    v_dot2c_f32_bf16 v8, s45, v128
    v_dot2c_f32_bf16 v9, v128, v128
    v_dot2c_f32_bf16 v8, s45, v129
    v_dot2c_f32_bf16 v9, v129, v129
    v_dot2c_f32_bf16 v8, s45, v130
    v_dot2c_f32_bf16 v9, v130, v130
    v_dot2c_f32_bf16 v8, s45, v131
    v_dot2c_f32_bf16 v9, v131, v131
    s_waitcnt lgkmcnt(11)
    v_dot2c_f32_bf16 v24, s45, v172
    v_dot2c_f32_bf16 v24, s45, v173
    s_waitcnt lgkmcnt(10)
    v_dot2c_f32_bf16 v24, s45, v174
    v_dot2c_f32_bf16 v24, s45, v175
    s_waitcnt lgkmcnt(5)
    v_dot2c_f32_bf16 v25, s45, v176
    v_dot2c_f32_bf16 v25, s45, v177
    s_waitcnt lgkmcnt(4)
    v_dot2c_f32_bf16 v25, s45, v178
    v_dot2c_f32_bf16 v25, s45, v179
    s_waitcnt vmcnt(4)
    s_barrier
    v_mfma_f32_32x32x16_bf16 v[212:227], v[156:159], v[124:127], v[212:227]
    ds_read_b128 v[132:135], v16 offset:8192
    ds_read_b128 v[136:139], v17 offset:8192
    ds_read_b64_tr_b16 v[148:149], v20 offset:49152
    ds_read_b64_tr_b16 v[150:151], v20 offset:49664
    ds_read_b64_tr_b16 v[152:153], v21 offset:49152
    ds_read_b64_tr_b16 v[154:155], v21 offset:49664
    v_mfma_f32_32x32x16_bf16 v[228:243], v[160:163], v[124:127], v[228:243]
    v_and_b32 v3, 19, v1
    v_bfe_u32 v32, v1, 2, 1
    v_lshl_add_u32 v3, v32, 3, v3
    v_bfe_u32 v32, v1, 3, 1
    v_lshl_add_u32 v3, v32, 2, v3
    v_lshlrev_b32 v3, 1, v3
    s_and_b32 s51, s52, 31
    s_lshl_b32 s51, s51, 7
    buffer_load_ushort v196, v3, s[24:27], s51 offen
    buffer_load_ushort v197, v3, s[24:27], s51 offen offset:64
    s_lshr_b32 m0, s57, 1
    s_mul_i32 s51, s63, 1344
    s_add_u32 m0, m0, 81920
    s_nop 0
    buffer_load_dwordx4 v15, s[12:15], s51 offen lds
    s_waitcnt lgkmcnt(8)
    v_mfma_f32_32x32x16_bf16 v[212:227], v[164:167], v[128:131], v[212:227]
    ds_read_b128 v[140:143], v18 offset:8192
    ds_read_b128 v[144:147], v19 offset:8192
    ds_read_b64_tr_b16 v[172:173], v22 offset:49152
    ds_read_b64_tr_b16 v[174:175], v22 offset:49664
    s_waitcnt lgkmcnt(10)
    v_mfma_f32_32x32x16_bf16 v[228:243], v[168:171], v[128:131], v[228:243]
    ds_read_b64_tr_b16 v[176:177], v23 offset:49152
    ds_read_b64_tr_b16 v[178:179], v23 offset:49664
    ds_read_b64_tr_b16 v[156:157], v20 offset:51200
    ds_read_b64_tr_b16 v[158:159], v20 offset:51712
    ds_read_b64_tr_b16 v[160:161], v21 offset:51200
    ds_read_b64_tr_b16 v[162:163], v21 offset:51712
    s_waitcnt lgkmcnt(12)
    v_mfma_f32_32x32x16_bf16 v[212:227], v[148:151], v[132:135], v[212:227]
    ds_read_b64_tr_b16 v[164:165], v20 offset:53248
    ds_read_b64_tr_b16 v[166:167], v20 offset:53760
    s_waitcnt lgkmcnt(12)
    v_mfma_f32_32x32x16_bf16 v[228:243], v[152:155], v[132:135], v[228:243]
    ds_read_b64_tr_b16 v[168:169], v21 offset:53248
    ds_read_b64_tr_b16 v[170:171], v21 offset:53760
    v_dot2c_f32_bf16 v8, s45, v132
    v_dot2c_f32_bf16 v9, v132, v132
    v_dot2c_f32_bf16 v8, s45, v133
    v_dot2c_f32_bf16 v9, v133, v133
    v_dot2c_f32_bf16 v8, s45, v134
    v_dot2c_f32_bf16 v9, v134, v134
    v_dot2c_f32_bf16 v8, s45, v135
    v_dot2c_f32_bf16 v9, v135, v135
    v_dot2c_f32_bf16 v8, s45, v136
    v_dot2c_f32_bf16 v9, v136, v136
    v_dot2c_f32_bf16 v8, s45, v137
    v_dot2c_f32_bf16 v9, v137, v137
    v_dot2c_f32_bf16 v8, s45, v138
    v_dot2c_f32_bf16 v9, v138, v138
    v_dot2c_f32_bf16 v8, s45, v139
    v_dot2c_f32_bf16 v9, v139, v139
    s_waitcnt lgkmcnt(13)
    v_dot2c_f32_bf16 v8, s45, v140
    v_dot2c_f32_bf16 v9, v140, v140
    v_dot2c_f32_bf16 v8, s45, v141
    v_dot2c_f32_bf16 v9, v141, v141
    v_dot2c_f32_bf16 v8, s45, v142
    v_dot2c_f32_bf16 v9, v142, v142
    v_dot2c_f32_bf16 v8, s45, v143
    v_dot2c_f32_bf16 v9, v143, v143
    s_waitcnt lgkmcnt(12)
    v_dot2c_f32_bf16 v8, s45, v144
    v_dot2c_f32_bf16 v9, v144, v144
    v_dot2c_f32_bf16 v8, s45, v145
    v_dot2c_f32_bf16 v9, v145, v145
    v_dot2c_f32_bf16 v8, s45, v146
    v_dot2c_f32_bf16 v9, v146, v146
    v_dot2c_f32_bf16 v8, s45, v147
    v_dot2c_f32_bf16 v9, v147, v147
    s_waitcnt lgkmcnt(11)
    v_dot2c_f32_bf16 v24, s45, v172
    v_dot2c_f32_bf16 v24, s45, v173
    s_waitcnt lgkmcnt(10)
    v_dot2c_f32_bf16 v24, s45, v174
    v_dot2c_f32_bf16 v24, s45, v175
    s_waitcnt lgkmcnt(9)
    v_dot2c_f32_bf16 v25, s45, v176
    v_dot2c_f32_bf16 v25, s45, v177
    s_waitcnt lgkmcnt(8)
    v_dot2c_f32_bf16 v25, s45, v178
    v_dot2c_f32_bf16 v25, s45, v179
    s_waitcnt lgkmcnt(6)
    v_mfma_f32_32x32x16_bf16 v[212:227], v[156:159], v[136:139], v[212:227]
    ds_read_b64_tr_b16 v[148:149], v20 offset:55296
    ds_read_b64_tr_b16 v[150:151], v20 offset:55808
    ds_read_b64_tr_b16 v[152:153], v21 offset:55296
    ds_read_b64_tr_b16 v[154:155], v21 offset:55808
    v_mov_b32 v5, v24
    s_waitcnt lgkmcnt(8)
    v_mfma_f32_32x32x16_bf16 v[228:243], v[160:163], v[136:139], v[228:243]
    v_permlane32_swap_b32 v5, v24
    v_add_f32 v24, v24, v5
    v_mov_b32 v5, v25
    s_nop 1
    v_permlane32_swap_b32 v5, v25
    v_add_f32 v25, v25, v5
    ds_write_b32 v28, v24 offset:0
    ds_write_b32 v28, v25 offset:512
    s_waitcnt lgkmcnt(8)
    v_mfma_f32_32x32x16_bf16 v[212:227], v[164:167], v[140:143], v[212:227]
    v_mov_b32 v4, v8
    s_nop 1
    v_permlane32_swap_b32 v4, v8
    v_add_f32 v8, v8, v4
    v_mov_b32 v5, v9
    s_nop 1
    v_permlane32_swap_b32 v5, v9
    v_add_f32 v9, v9, v5
    s_waitcnt lgkmcnt(0)
    s_barrier
    v_mfma_f32_32x32x16_bf16 v[228:243], v[168:171], v[140:143], v[228:243]
    ds_read_b128 v[172:175], v27 offset:0
    ds_read_b128 v[176:179], v27 offset:512
    v_mfma_f32_32x32x16_bf16 v[212:227], v[148:151], v[144:147], v[212:227]
    v_mul_f32 v32, 0xbb124925, v8
    v_mul_f32 v9, 0x3b124925, v9
    v_fma_f32 v9, -v32, v32, v9
    v_max_f32 v9, 0, v9
    v_add_f32 v9, 0x3727c5ac, v9
    v_rsq_f32 v33, v9
    v_mfma_f32_32x32x16_bf16 v[228:243], v[152:155], v[144:147], v[228:243]
    v_cvt_pk_bf16_f32 v180, v32, v32
    v_and_b32 v4, 0xffff0000, v180
    v_sub_f32 v4, v32, v4
    v_cvt_pk_bf16_f32 v4, v4, v4
    v_cndmask_b32 v180, v180, v4, vcc
    v_mov_b32 v32, v33
    s_waitcnt lgkmcnt(1)
    v_add_f32 v172, v172, v173
    v_add_f32 v174, v174, v175
    v_add_f32 v172, v172, v174
    v_cvt_pk_bf16_f32 v4, v172, v172
    v_and_b32 v4, 0xffff0000, v4
    v_sub_f32 v4, v172, v4
    v_cvt_pk_bf16_f32 v184, v172, v4
    s_nop 1
    v_mfma_f32_32x32x16_bf16 v[212:227], v[184:187], v[180:183], v[212:227]
    s_waitcnt lgkmcnt(0)
    v_add_f32 v176, v176, v177
    v_add_f32 v178, v178, v179
    v_add_f32 v176, v176, v178
    v_cvt_pk_bf16_f32 v4, v176, v176
    v_and_b32 v4, 0xffff0000, v4
    v_sub_f32 v4, v176, v4
    v_cvt_pk_bf16_f32 v188, v176, v4
    s_nop 1
    v_mfma_f32_32x32x16_bf16 v[228:243], v[188:191], v[180:183], v[228:243]
    s_cmp_ge_u32 s47, 14
    s_cbranch_scc1 L_aux
    v_pk_mul_f32 v[212:213], v[212:213], v[32:33]
    v_pk_mul_f32 v[214:215], v[214:215], v[32:33]
    v_pk_mul_f32 v[216:217], v[216:217], v[32:33]
    v_pk_mul_f32 v[218:219], v[218:219], v[32:33]
    v_cvt_pk_bf16_f32 v212, v212, v213
    v_cvt_pk_bf16_f32 v213, v214, v215
    v_cvt_pk_bf16_f32 v214, v216, v217
    v_cvt_pk_bf16_f32 v215, v218, v219
    buffer_store_dwordx4 v[212:215], v2, s[40:43], s48 offen offset:0 sc1
    v_pk_mul_f32 v[220:221], v[220:221], v[32:33]
    v_pk_mul_f32 v[222:223], v[222:223], v[32:33]
    v_pk_mul_f32 v[224:225], v[224:225], v[32:33]
    v_pk_mul_f32 v[226:227], v[226:227], v[32:33]
    v_cvt_pk_bf16_f32 v220, v220, v221
    v_cvt_pk_bf16_f32 v221, v222, v223
    v_cvt_pk_bf16_f32 v222, v224, v225
    v_cvt_pk_bf16_f32 v223, v226, v227
    buffer_store_dwordx4 v[220:223], v2, s[40:43], s48 offen offset:1024 sc1
    v_pk_mul_f32 v[228:229], v[228:229], v[32:33]
    v_pk_mul_f32 v[230:231], v[230:231], v[32:33]
    v_pk_mul_f32 v[232:233], v[232:233], v[32:33]
    v_pk_mul_f32 v[234:235], v[234:235], v[32:33]
    v_cvt_pk_bf16_f32 v228, v228, v229
    v_cvt_pk_bf16_f32 v229, v230, v231
    v_cvt_pk_bf16_f32 v230, v232, v233
    v_cvt_pk_bf16_f32 v231, v234, v235
    buffer_store_dwordx4 v[228:231], v2, s[40:43], s48 offen offset:2048 sc1
    v_pk_mul_f32 v[236:237], v[236:237], v[32:33]
    v_pk_mul_f32 v[238:239], v[238:239], v[32:33]
    v_pk_mul_f32 v[240:241], v[240:241], v[32:33]
    v_pk_mul_f32 v[242:243], v[242:243], v[32:33]
    v_cvt_pk_bf16_f32 v236, v236, v237
    v_cvt_pk_bf16_f32 v237, v238, v239
    v_cvt_pk_bf16_f32 v238, v240, v241
    v_cvt_pk_bf16_f32 v239, v242, v243
    buffer_store_dwordx4 v[236:239], v2, s[40:43], s48 offen offset:3072 sc1
    s_waitcnt vmcnt(4)
    s_branch L_p1_done
L_p1_v:
    v_bfe_u32 v3, v1, 2, 2
    v_lshrrev_b32 v4, 5, v1
    v_lshl_add_u32 v4, v4, 3, v3
    v_mul_u32_u24 v20, 128, v4
    v_lshrrev_b32 v3, 1, v3
    v_lshl_add_u32 v20, v3, 6, v20
    v_bfe_u32 v3, v1, 4, 1
    v_lshl_add_u32 v20, v3, 5, v20
    v_and_b32 v3, 3, v1
    v_lshl_add_u32 v20, v3, 3, v20
    v_xor_b32 v21, 64, v20
    v_add_u32 v22, s57, v20
    v_add_u32 v23, s57, v21
    v_lshrrev_b32 v31, 5, v1
    v_mul_u32_u24 v31, 6656, v31
    v_add_u32 v31, v31, v2
    s_mul_i32 s50, s55, 57472
    s_lshl_b32 s49, s47, 10
    s_add_u32 s48, s50, s49
    s_add_u32 s48, s48, 21504
    s_lshl_b32 s49, s47, 4
    s_add_u32 s50, s50, s49
    s_add_u32 s50, s50, 57232
    s_add_u32 s49, s48, 14336
    s_add_u32 m0, s54, 4096
    s_mul_i32 s51, s4, s56
    buffer_load_dwordx4 v6, s[8:11], s4 offen lds
    buffer_load_dwordx4 v7, s[8:11], s4 offen offset:1024 lds
    buffer_load_dwordx4 v34, s[8:11], s4 offen offset:2048 lds
    buffer_load_dwordx4 v35, s[8:11], s4 offen offset:3072 lds
    s_add_u32 m0, s57, 8192
    s_nop 0
    buffer_load_dwordx4 v12, s[96:99], s51 offen lds
    buffer_load_dwordx4 v13, s[96:99], s51 offen offset:1024 lds
    s_waitcnt lgkmcnt(0)
    s_waitcnt vmcnt(8)
    s_barrier
    ds_read_b128 v[36:39], v16 offset:0
    ds_read_b64_tr_b16 v[148:149], v20 offset:0
    ds_read_b64_tr_b16 v[150:151], v20 offset:512
    ds_read_b64_tr_b16 v[152:153], v21 offset:0
    ds_read_b64_tr_b16 v[154:155], v21 offset:512
    ds_read_b128 v[40:43], v17 offset:0
    ds_read_b64_tr_b16 v[156:157], v20 offset:2048
    ds_read_b64_tr_b16 v[158:159], v20 offset:2560
    ds_read_b64_tr_b16 v[160:161], v21 offset:2048
    ds_read_b64_tr_b16 v[162:163], v21 offset:2560
    ds_read_b128 v[44:47], v18 offset:0
    ds_read_b128 v[48:51], v19 offset:0
    s_waitcnt lgkmcnt(9)
    v_mfma_f32_32x32x16_bf16 v[212:227], v[36:39], v[148:151], 0
    ds_read_b64_tr_b16 v[172:173], v22 offset:0
    ds_read_b64_tr_b16 v[174:175], v22 offset:512
    ds_read_b64_tr_b16 v[164:165], v20 offset:4096
    ds_read_b64_tr_b16 v[166:167], v20 offset:4608
    ds_read_b64_tr_b16 v[168:169], v21 offset:4096
    ds_read_b64_tr_b16 v[170:171], v21 offset:4608
    s_add_u32 m0, s54, 8192
    s_mul_i32 s51, s5, s56
    buffer_load_dwordx4 v6, s[8:11], s5 offen lds
    s_waitcnt lgkmcnt(13)
    v_mfma_f32_32x32x16_bf16 v[228:243], v[36:39], v[152:155], 0
    buffer_load_dwordx4 v7, s[8:11], s5 offen offset:1024 lds
    buffer_load_dwordx4 v34, s[8:11], s5 offen offset:2048 lds
    buffer_load_dwordx4 v35, s[8:11], s5 offen offset:3072 lds
    s_waitcnt lgkmcnt(10)
    v_mfma_f32_32x32x16_bf16 v[212:227], v[40:43], v[156:159], v[212:227]
    ds_read_b64_tr_b16 v[176:177], v23 offset:0
    ds_read_b64_tr_b16 v[178:179], v23 offset:512
    ds_read_b64_tr_b16 v[148:149], v20 offset:6144
    ds_read_b64_tr_b16 v[150:151], v20 offset:6656
    ds_read_b64_tr_b16 v[152:153], v21 offset:6144
    ds_read_b64_tr_b16 v[154:155], v21 offset:6656
    s_add_u32 m0, s57, 16384
    s_nop 0
    buffer_load_dwordx4 v12, s[96:99], s51 offen lds
    s_waitcnt lgkmcnt(14)
    v_mfma_f32_32x32x16_bf16 v[228:243], v[40:43], v[160:163], v[228:243]
    buffer_load_dwordx4 v13, s[96:99], s51 offen offset:1024 lds
    s_lshr_b32 m0, s57, 1
    s_mul_i32 s51, s3, 1344
    s_add_u32 m0, m0, 57344
    s_nop 0
    buffer_load_dwordx4 v15, s[12:15], s51 offen lds
    v_dot2c_f32_bf16 v8, s45, v36
    v_dot2c_f32_bf16 v9, v36, v36
    v_dot2c_f32_bf16 v8, s45, v37
    v_dot2c_f32_bf16 v9, v37, v37
    v_dot2c_f32_bf16 v8, s45, v38
    v_dot2c_f32_bf16 v9, v38, v38
    v_dot2c_f32_bf16 v8, s45, v39
    v_dot2c_f32_bf16 v9, v39, v39
    v_dot2c_f32_bf16 v8, s45, v40
    v_dot2c_f32_bf16 v9, v40, v40
    v_dot2c_f32_bf16 v8, s45, v41
    v_dot2c_f32_bf16 v9, v41, v41
    v_dot2c_f32_bf16 v8, s45, v42
    v_dot2c_f32_bf16 v9, v42, v42
    v_dot2c_f32_bf16 v8, s45, v43
    v_dot2c_f32_bf16 v9, v43, v43
    s_waitcnt lgkmcnt(13)
    v_dot2c_f32_bf16 v8, s45, v44
    v_dot2c_f32_bf16 v9, v44, v44
    v_dot2c_f32_bf16 v8, s45, v45
    v_dot2c_f32_bf16 v9, v45, v45
    v_dot2c_f32_bf16 v8, s45, v46
    v_dot2c_f32_bf16 v9, v46, v46
    v_dot2c_f32_bf16 v8, s45, v47
    v_dot2c_f32_bf16 v9, v47, v47
    s_waitcnt lgkmcnt(12)
    v_dot2c_f32_bf16 v8, s45, v48
    v_dot2c_f32_bf16 v9, v48, v48
    v_dot2c_f32_bf16 v8, s45, v49
    v_dot2c_f32_bf16 v9, v49, v49
    v_dot2c_f32_bf16 v8, s45, v50
    v_dot2c_f32_bf16 v9, v50, v50
    v_dot2c_f32_bf16 v8, s45, v51
    v_dot2c_f32_bf16 v9, v51, v51
    s_waitcnt lgkmcnt(11)
    v_dot2c_f32_bf16 v24, s45, v172
    v_dot2c_f32_bf16 v24, s45, v173
    s_waitcnt lgkmcnt(10)
    v_dot2c_f32_bf16 v24, s45, v174
    v_dot2c_f32_bf16 v24, s45, v175
    s_waitcnt lgkmcnt(5)
    v_dot2c_f32_bf16 v25, s45, v176
    v_dot2c_f32_bf16 v25, s45, v177
    s_waitcnt lgkmcnt(4)
    v_dot2c_f32_bf16 v25, s45, v178
    v_dot2c_f32_bf16 v25, s45, v179
    s_waitcnt vmcnt(7)
    s_barrier
    v_mfma_f32_32x32x16_bf16 v[212:227], v[44:47], v[164:167], v[212:227]
    ds_read_b128 v[52:55], v16 offset:4096
    ds_read_b64_tr_b16 v[156:157], v20 offset:8192
    ds_read_b64_tr_b16 v[158:159], v20 offset:8704
    ds_read_b64_tr_b16 v[160:161], v21 offset:8192
    ds_read_b64_tr_b16 v[162:163], v21 offset:8704
    v_mfma_f32_32x32x16_bf16 v[228:243], v[44:47], v[168:171], v[228:243]
    s_add_u32 m0, s54, 12288
    s_mul_i32 s51, s6, s56
    buffer_load_dwordx4 v6, s[8:11], s6 offen lds
    buffer_load_dwordx4 v7, s[8:11], s6 offen offset:1024 lds
    s_waitcnt lgkmcnt(7)
    v_mfma_f32_32x32x16_bf16 v[212:227], v[48:51], v[148:151], v[212:227]
    ds_read_b128 v[56:59], v17 offset:4096
    ds_read_b64_tr_b16 v[164:165], v20 offset:10240
    ds_read_b64_tr_b16 v[166:167], v20 offset:10752
    ds_read_b64_tr_b16 v[168:169], v21 offset:10240
    s_waitcnt lgkmcnt(9)
    v_mfma_f32_32x32x16_bf16 v[228:243], v[48:51], v[152:155], v[228:243]
    ds_read_b64_tr_b16 v[170:171], v21 offset:10752
    buffer_load_dwordx4 v34, s[8:11], s6 offen offset:2048 lds
    buffer_load_dwordx4 v35, s[8:11], s6 offen offset:3072 lds
    s_waitcnt lgkmcnt(7)
    v_mfma_f32_32x32x16_bf16 v[212:227], v[52:55], v[156:159], v[212:227]
    ds_read_b128 v[60:63], v18 offset:4096
    ds_read_b128 v[64:67], v19 offset:4096
    ds_read_b64_tr_b16 v[172:173], v22 offset:8192
    ds_read_b64_tr_b16 v[174:175], v22 offset:8704
    ds_read_b64_tr_b16 v[148:149], v20 offset:12288
    s_waitcnt lgkmcnt(10)
    v_mfma_f32_32x32x16_bf16 v[228:243], v[52:55], v[160:163], v[228:243]
    ds_read_b64_tr_b16 v[150:151], v20 offset:12800
    ds_read_b64_tr_b16 v[152:153], v21 offset:12288
    ds_read_b64_tr_b16 v[154:155], v21 offset:12800
    s_add_u32 m0, s57, 24576
    s_nop 0
    buffer_load_dwordx4 v12, s[96:99], s51 offen lds
    s_waitcnt lgkmcnt(10)
    v_mfma_f32_32x32x16_bf16 v[212:227], v[56:59], v[164:167], v[212:227]
    ds_read_b64_tr_b16 v[176:177], v23 offset:8192
    ds_read_b64_tr_b16 v[178:179], v23 offset:8704
    ds_read_b64_tr_b16 v[156:157], v20 offset:14336
    ds_read_b64_tr_b16 v[158:159], v20 offset:14848
    ds_read_b64_tr_b16 v[160:161], v21 offset:14336
    ds_read_b64_tr_b16 v[162:163], v21 offset:14848
    s_waitcnt lgkmcnt(14)
    v_mfma_f32_32x32x16_bf16 v[228:243], v[56:59], v[168:171], v[228:243]
    buffer_load_dwordx4 v13, s[96:99], s51 offen offset:1024 lds
    s_lshr_b32 m0, s57, 1
    s_mul_i32 s51, s4, 1344
    s_add_u32 m0, m0, 61440
    s_nop 0
    buffer_load_dwordx4 v15, s[12:15], s51 offen lds
    v_dot2c_f32_bf16 v8, s45, v52
    v_dot2c_f32_bf16 v9, v52, v52
    v_dot2c_f32_bf16 v8, s45, v53
    v_dot2c_f32_bf16 v9, v53, v53
    v_dot2c_f32_bf16 v8, s45, v54
    v_dot2c_f32_bf16 v9, v54, v54
    v_dot2c_f32_bf16 v8, s45, v55
    v_dot2c_f32_bf16 v9, v55, v55
    v_dot2c_f32_bf16 v8, s45, v56
    v_dot2c_f32_bf16 v9, v56, v56
    v_dot2c_f32_bf16 v8, s45, v57
    v_dot2c_f32_bf16 v9, v57, v57
    v_dot2c_f32_bf16 v8, s45, v58
    v_dot2c_f32_bf16 v9, v58, v58
    v_dot2c_f32_bf16 v8, s45, v59
    v_dot2c_f32_bf16 v9, v59, v59
    s_waitcnt lgkmcnt(13)
    v_dot2c_f32_bf16 v8, s45, v60
    v_dot2c_f32_bf16 v9, v60, v60
    v_dot2c_f32_bf16 v8, s45, v61
    v_dot2c_f32_bf16 v9, v61, v61
    v_dot2c_f32_bf16 v8, s45, v62
    v_dot2c_f32_bf16 v9, v62, v62
    v_dot2c_f32_bf16 v8, s45, v63
    v_dot2c_f32_bf16 v9, v63, v63
    s_waitcnt lgkmcnt(12)
    v_dot2c_f32_bf16 v8, s45, v64
    v_dot2c_f32_bf16 v9, v64, v64
    v_dot2c_f32_bf16 v8, s45, v65
    v_dot2c_f32_bf16 v9, v65, v65
    v_dot2c_f32_bf16 v8, s45, v66
    v_dot2c_f32_bf16 v9, v66, v66
    v_dot2c_f32_bf16 v8, s45, v67
    v_dot2c_f32_bf16 v9, v67, v67
    s_waitcnt lgkmcnt(11)
    v_dot2c_f32_bf16 v24, s45, v172
    v_dot2c_f32_bf16 v24, s45, v173
    s_waitcnt lgkmcnt(10)
    v_dot2c_f32_bf16 v24, s45, v174
    v_dot2c_f32_bf16 v24, s45, v175
    s_waitcnt lgkmcnt(5)
    v_dot2c_f32_bf16 v25, s45, v176
    v_dot2c_f32_bf16 v25, s45, v177
    s_waitcnt lgkmcnt(4)
    v_dot2c_f32_bf16 v25, s45, v178
    v_dot2c_f32_bf16 v25, s45, v179
    s_waitcnt vmcnt(8)
    s_barrier
    v_mfma_f32_32x32x16_bf16 v[212:227], v[60:63], v[148:151], v[212:227]
    ds_read_b128 v[68:71], v16 offset:8192
    ds_read_b64_tr_b16 v[164:165], v20 offset:16384
    ds_read_b64_tr_b16 v[166:167], v20 offset:16896
    ds_read_b64_tr_b16 v[168:169], v21 offset:16384
    ds_read_b64_tr_b16 v[170:171], v21 offset:16896
    v_mfma_f32_32x32x16_bf16 v[228:243], v[60:63], v[152:155], v[228:243]
    s_add_u32 m0, s54, 0
    s_mul_i32 s51, s7, s56
    buffer_load_dwordx4 v6, s[8:11], s7 offen lds
    buffer_load_dwordx4 v7, s[8:11], s7 offen offset:1024 lds
    s_waitcnt lgkmcnt(7)
    v_mfma_f32_32x32x16_bf16 v[212:227], v[64:67], v[156:159], v[212:227]
    ds_read_b128 v[72:75], v17 offset:8192
    ds_read_b64_tr_b16 v[148:149], v20 offset:18432
    ds_read_b64_tr_b16 v[150:151], v20 offset:18944
    ds_read_b64_tr_b16 v[152:153], v21 offset:18432
    s_waitcnt lgkmcnt(9)
    v_mfma_f32_32x32x16_bf16 v[228:243], v[64:67], v[160:163], v[228:243]
    ds_read_b64_tr_b16 v[154:155], v21 offset:18944
    buffer_load_dwordx4 v34, s[8:11], s7 offen offset:2048 lds
    buffer_load_dwordx4 v35, s[8:11], s7 offen offset:3072 lds
    s_waitcnt lgkmcnt(7)
    v_mfma_f32_32x32x16_bf16 v[212:227], v[68:71], v[164:167], v[212:227]
    ds_read_b128 v[76:79], v18 offset:8192
    ds_read_b128 v[80:83], v19 offset:8192
    ds_read_b64_tr_b16 v[172:173], v22 offset:16384
    ds_read_b64_tr_b16 v[174:175], v22 offset:16896
    ds_read_b64_tr_b16 v[156:157], v20 offset:20480
    s_waitcnt lgkmcnt(10)
    v_mfma_f32_32x32x16_bf16 v[228:243], v[68:71], v[168:171], v[228:243]
    ds_read_b64_tr_b16 v[158:159], v20 offset:20992
    ds_read_b64_tr_b16 v[160:161], v21 offset:20480
    ds_read_b64_tr_b16 v[162:163], v21 offset:20992
    s_add_u32 m0, s57, 32768
    s_nop 0
    buffer_load_dwordx4 v12, s[96:99], s51 offen lds
    s_waitcnt lgkmcnt(10)
    v_mfma_f32_32x32x16_bf16 v[212:227], v[72:75], v[148:151], v[212:227]
    ds_read_b64_tr_b16 v[176:177], v23 offset:16384
    ds_read_b64_tr_b16 v[178:179], v23 offset:16896
    ds_read_b64_tr_b16 v[164:165], v20 offset:22528
    ds_read_b64_tr_b16 v[166:167], v20 offset:23040
    ds_read_b64_tr_b16 v[168:169], v21 offset:22528
    ds_read_b64_tr_b16 v[170:171], v21 offset:23040
    s_waitcnt lgkmcnt(14)
    v_mfma_f32_32x32x16_bf16 v[228:243], v[72:75], v[152:155], v[228:243]
    buffer_load_dwordx4 v13, s[96:99], s51 offen offset:1024 lds
    s_lshr_b32 m0, s57, 1
    s_mul_i32 s51, s5, 1344
    s_add_u32 m0, m0, 65536
    s_nop 0
    buffer_load_dwordx4 v15, s[12:15], s51 offen lds
    v_dot2c_f32_bf16 v8, s45, v68
    v_dot2c_f32_bf16 v9, v68, v68
    v_dot2c_f32_bf16 v8, s45, v69
    v_dot2c_f32_bf16 v9, v69, v69
    v_dot2c_f32_bf16 v8, s45, v70
    v_dot2c_f32_bf16 v9, v70, v70
    v_dot2c_f32_bf16 v8, s45, v71
    v_dot2c_f32_bf16 v9, v71, v71
    v_dot2c_f32_bf16 v8, s45, v72
    v_dot2c_f32_bf16 v9, v72, v72
    v_dot2c_f32_bf16 v8, s45, v73
    v_dot2c_f32_bf16 v9, v73, v73
    v_dot2c_f32_bf16 v8, s45, v74
    v_dot2c_f32_bf16 v9, v74, v74
    v_dot2c_f32_bf16 v8, s45, v75
    v_dot2c_f32_bf16 v9, v75, v75
    s_waitcnt lgkmcnt(13)
    v_dot2c_f32_bf16 v8, s45, v76
    v_dot2c_f32_bf16 v9, v76, v76
    v_dot2c_f32_bf16 v8, s45, v77
    v_dot2c_f32_bf16 v9, v77, v77
    v_dot2c_f32_bf16 v8, s45, v78
    v_dot2c_f32_bf16 v9, v78, v78
    v_dot2c_f32_bf16 v8, s45, v79
    v_dot2c_f32_bf16 v9, v79, v79
    s_waitcnt lgkmcnt(12)
    v_dot2c_f32_bf16 v8, s45, v80
    v_dot2c_f32_bf16 v9, v80, v80
    v_dot2c_f32_bf16 v8, s45, v81
    v_dot2c_f32_bf16 v9, v81, v81
    v_dot2c_f32_bf16 v8, s45, v82
    v_dot2c_f32_bf16 v9, v82, v82
    v_dot2c_f32_bf16 v8, s45, v83
    v_dot2c_f32_bf16 v9, v83, v83
    s_waitcnt lgkmcnt(11)
    v_dot2c_f32_bf16 v24, s45, v172
    v_dot2c_f32_bf16 v24, s45, v173
    s_waitcnt lgkmcnt(10)
    v_dot2c_f32_bf16 v24, s45, v174
    v_dot2c_f32_bf16 v24, s45, v175
    s_waitcnt lgkmcnt(5)
    v_dot2c_f32_bf16 v25, s45, v176
    v_dot2c_f32_bf16 v25, s45, v177
    s_waitcnt lgkmcnt(4)
    v_dot2c_f32_bf16 v25, s45, v178
    v_dot2c_f32_bf16 v25, s45, v179
    s_waitcnt vmcnt(8)
    s_barrier
    v_mfma_f32_32x32x16_bf16 v[212:227], v[76:79], v[156:159], v[212:227]
    ds_read_b128 v[84:87], v16 offset:12288
    ds_read_b64_tr_b16 v[148:149], v20 offset:24576
    ds_read_b64_tr_b16 v[150:151], v20 offset:25088
    ds_read_b64_tr_b16 v[152:153], v21 offset:24576
    ds_read_b64_tr_b16 v[154:155], v21 offset:25088
    v_mfma_f32_32x32x16_bf16 v[228:243], v[76:79], v[160:163], v[228:243]
    s_add_u32 m0, s54, 4096
    s_mul_i32 s51, s62, s56
    buffer_load_dwordx4 v6, s[8:11], s62 offen lds
    buffer_load_dwordx4 v7, s[8:11], s62 offen offset:1024 lds
    s_waitcnt lgkmcnt(7)
    v_mfma_f32_32x32x16_bf16 v[212:227], v[80:83], v[164:167], v[212:227]
    ds_read_b128 v[88:91], v17 offset:12288
    ds_read_b64_tr_b16 v[156:157], v20 offset:26624
    ds_read_b64_tr_b16 v[158:159], v20 offset:27136
    ds_read_b64_tr_b16 v[160:161], v21 offset:26624
    s_waitcnt lgkmcnt(9)
    v_mfma_f32_32x32x16_bf16 v[228:243], v[80:83], v[168:171], v[228:243]
    ds_read_b64_tr_b16 v[162:163], v21 offset:27136
    buffer_load_dwordx4 v34, s[8:11], s62 offen offset:2048 lds
    buffer_load_dwordx4 v35, s[8:11], s62 offen offset:3072 lds
    s_waitcnt lgkmcnt(7)
    v_mfma_f32_32x32x16_bf16 v[212:227], v[84:87], v[148:151], v[212:227]
    ds_read_b128 v[92:95], v18 offset:12288
    ds_read_b128 v[96:99], v19 offset:12288
    ds_read_b64_tr_b16 v[172:173], v22 offset:24576
    ds_read_b64_tr_b16 v[174:175], v22 offset:25088
    ds_read_b64_tr_b16 v[164:165], v20 offset:28672
    s_waitcnt lgkmcnt(10)
    v_mfma_f32_32x32x16_bf16 v[228:243], v[84:87], v[152:155], v[228:243]
    ds_read_b64_tr_b16 v[166:167], v20 offset:29184
    ds_read_b64_tr_b16 v[168:169], v21 offset:28672
    ds_read_b64_tr_b16 v[170:171], v21 offset:29184
    s_add_u32 m0, s57, 40960
    s_nop 0
    buffer_load_dwordx4 v12, s[96:99], s51 offen lds
    s_waitcnt lgkmcnt(10)
    v_mfma_f32_32x32x16_bf16 v[212:227], v[88:91], v[156:159], v[212:227]
    ds_read_b64_tr_b16 v[176:177], v23 offset:24576
    ds_read_b64_tr_b16 v[178:179], v23 offset:25088
    ds_read_b64_tr_b16 v[148:149], v20 offset:30720
    ds_read_b64_tr_b16 v[150:151], v20 offset:31232
    ds_read_b64_tr_b16 v[152:153], v21 offset:30720
    ds_read_b64_tr_b16 v[154:155], v21 offset:31232
    s_waitcnt lgkmcnt(14)
    v_mfma_f32_32x32x16_bf16 v[228:243], v[88:91], v[160:163], v[228:243]
    buffer_load_dwordx4 v13, s[96:99], s51 offen offset:1024 lds
    s_lshr_b32 m0, s57, 1
    s_mul_i32 s51, s6, 1344
    s_add_u32 m0, m0, 69632
    s_nop 0
    buffer_load_dwordx4 v15, s[12:15], s51 offen lds
    v_dot2c_f32_bf16 v8, s45, v84
    v_dot2c_f32_bf16 v9, v84, v84
    v_dot2c_f32_bf16 v8, s45, v85
    v_dot2c_f32_bf16 v9, v85, v85
    v_dot2c_f32_bf16 v8, s45, v86
    v_dot2c_f32_bf16 v9, v86, v86
    v_dot2c_f32_bf16 v8, s45, v87
    v_dot2c_f32_bf16 v9, v87, v87
    v_dot2c_f32_bf16 v8, s45, v88
    v_dot2c_f32_bf16 v9, v88, v88
    v_dot2c_f32_bf16 v8, s45, v89
    v_dot2c_f32_bf16 v9, v89, v89
    v_dot2c_f32_bf16 v8, s45, v90
    v_dot2c_f32_bf16 v9, v90, v90
    v_dot2c_f32_bf16 v8, s45, v91
    v_dot2c_f32_bf16 v9, v91, v91
    s_waitcnt lgkmcnt(13)
    v_dot2c_f32_bf16 v8, s45, v92
    v_dot2c_f32_bf16 v9, v92, v92
    v_dot2c_f32_bf16 v8, s45, v93
    v_dot2c_f32_bf16 v9, v93, v93
    v_dot2c_f32_bf16 v8, s45, v94
    v_dot2c_f32_bf16 v9, v94, v94
    v_dot2c_f32_bf16 v8, s45, v95
    v_dot2c_f32_bf16 v9, v95, v95
    s_waitcnt lgkmcnt(12)
    v_dot2c_f32_bf16 v8, s45, v96
    v_dot2c_f32_bf16 v9, v96, v96
    v_dot2c_f32_bf16 v8, s45, v97
    v_dot2c_f32_bf16 v9, v97, v97
    v_dot2c_f32_bf16 v8, s45, v98
    v_dot2c_f32_bf16 v9, v98, v98
    v_dot2c_f32_bf16 v8, s45, v99
    v_dot2c_f32_bf16 v9, v99, v99
    s_waitcnt lgkmcnt(11)
    v_dot2c_f32_bf16 v24, s45, v172
    v_dot2c_f32_bf16 v24, s45, v173
    s_waitcnt lgkmcnt(10)
    v_dot2c_f32_bf16 v24, s45, v174
    v_dot2c_f32_bf16 v24, s45, v175
    s_waitcnt lgkmcnt(5)
    v_dot2c_f32_bf16 v25, s45, v176
    v_dot2c_f32_bf16 v25, s45, v177
    s_waitcnt lgkmcnt(4)
    v_dot2c_f32_bf16 v25, s45, v178
    v_dot2c_f32_bf16 v25, s45, v179
    s_waitcnt vmcnt(8)
    s_barrier
    v_mfma_f32_32x32x16_bf16 v[212:227], v[92:95], v[164:167], v[212:227]
    ds_read_b128 v[100:103], v16 offset:0
    ds_read_b64_tr_b16 v[156:157], v20 offset:32768
    ds_read_b64_tr_b16 v[158:159], v20 offset:33280
    ds_read_b64_tr_b16 v[160:161], v21 offset:32768
    ds_read_b64_tr_b16 v[162:163], v21 offset:33280
    v_mfma_f32_32x32x16_bf16 v[228:243], v[92:95], v[168:171], v[228:243]
    s_add_u32 m0, s54, 8192
    s_mul_i32 s51, s63, s56
    buffer_load_dwordx4 v6, s[8:11], s63 offen lds
    buffer_load_dwordx4 v7, s[8:11], s63 offen offset:1024 lds
    s_waitcnt lgkmcnt(7)
    v_mfma_f32_32x32x16_bf16 v[212:227], v[96:99], v[148:151], v[212:227]
    ds_read_b128 v[104:107], v17 offset:0
    ds_read_b64_tr_b16 v[164:165], v20 offset:34816
    ds_read_b64_tr_b16 v[166:167], v20 offset:35328
    ds_read_b64_tr_b16 v[168:169], v21 offset:34816
    s_waitcnt lgkmcnt(9)
    v_mfma_f32_32x32x16_bf16 v[228:243], v[96:99], v[152:155], v[228:243]
    ds_read_b64_tr_b16 v[170:171], v21 offset:35328
    buffer_load_dwordx4 v34, s[8:11], s63 offen offset:2048 lds
    buffer_load_dwordx4 v35, s[8:11], s63 offen offset:3072 lds
    s_waitcnt lgkmcnt(7)
    v_mfma_f32_32x32x16_bf16 v[212:227], v[100:103], v[156:159], v[212:227]
    ds_read_b128 v[108:111], v18 offset:0
    ds_read_b128 v[112:115], v19 offset:0
    ds_read_b64_tr_b16 v[172:173], v22 offset:32768
    ds_read_b64_tr_b16 v[174:175], v22 offset:33280
    ds_read_b64_tr_b16 v[148:149], v20 offset:36864
    s_waitcnt lgkmcnt(10)
    v_mfma_f32_32x32x16_bf16 v[228:243], v[100:103], v[160:163], v[228:243]
    ds_read_b64_tr_b16 v[150:151], v20 offset:37376
    ds_read_b64_tr_b16 v[152:153], v21 offset:36864
    ds_read_b64_tr_b16 v[154:155], v21 offset:37376
    s_add_u32 m0, s57, 49152
    s_nop 0
    buffer_load_dwordx4 v12, s[96:99], s51 offen lds
    s_waitcnt lgkmcnt(10)
    v_mfma_f32_32x32x16_bf16 v[212:227], v[104:107], v[164:167], v[212:227]
    ds_read_b64_tr_b16 v[176:177], v23 offset:32768
    ds_read_b64_tr_b16 v[178:179], v23 offset:33280
    ds_read_b64_tr_b16 v[156:157], v20 offset:38912
    ds_read_b64_tr_b16 v[158:159], v20 offset:39424
    ds_read_b64_tr_b16 v[160:161], v21 offset:38912
    ds_read_b64_tr_b16 v[162:163], v21 offset:39424
    s_waitcnt lgkmcnt(14)
    v_mfma_f32_32x32x16_bf16 v[228:243], v[104:107], v[168:171], v[228:243]
    buffer_load_dwordx4 v13, s[96:99], s51 offen offset:1024 lds
    s_lshr_b32 m0, s57, 1
    s_mul_i32 s51, s7, 1344
    s_add_u32 m0, m0, 73728
    s_nop 0
    buffer_load_dwordx4 v15, s[12:15], s51 offen lds
    v_dot2c_f32_bf16 v8, s45, v100
    v_dot2c_f32_bf16 v9, v100, v100
    v_dot2c_f32_bf16 v8, s45, v101
    v_dot2c_f32_bf16 v9, v101, v101
    v_dot2c_f32_bf16 v8, s45, v102
    v_dot2c_f32_bf16 v9, v102, v102
    v_dot2c_f32_bf16 v8, s45, v103
    v_dot2c_f32_bf16 v9, v103, v103
    v_dot2c_f32_bf16 v8, s45, v104
    v_dot2c_f32_bf16 v9, v104, v104
    v_dot2c_f32_bf16 v8, s45, v105
    v_dot2c_f32_bf16 v9, v105, v105
    v_dot2c_f32_bf16 v8, s45, v106
    v_dot2c_f32_bf16 v9, v106, v106
    v_dot2c_f32_bf16 v8, s45, v107
    v_dot2c_f32_bf16 v9, v107, v107
    s_waitcnt lgkmcnt(13)
    v_dot2c_f32_bf16 v8, s45, v108
    v_dot2c_f32_bf16 v9, v108, v108
    v_dot2c_f32_bf16 v8, s45, v109
    v_dot2c_f32_bf16 v9, v109, v109
    v_dot2c_f32_bf16 v8, s45, v110
    v_dot2c_f32_bf16 v9, v110, v110
    v_dot2c_f32_bf16 v8, s45, v111
    v_dot2c_f32_bf16 v9, v111, v111
    s_waitcnt lgkmcnt(12)
    v_dot2c_f32_bf16 v8, s45, v112
    v_dot2c_f32_bf16 v9, v112, v112
    v_dot2c_f32_bf16 v8, s45, v113
    v_dot2c_f32_bf16 v9, v113, v113
    v_dot2c_f32_bf16 v8, s45, v114
    v_dot2c_f32_bf16 v9, v114, v114
    v_dot2c_f32_bf16 v8, s45, v115
    v_dot2c_f32_bf16 v9, v115, v115
    s_waitcnt lgkmcnt(11)
    v_dot2c_f32_bf16 v24, s45, v172
    v_dot2c_f32_bf16 v24, s45, v173
    s_waitcnt lgkmcnt(10)
    v_dot2c_f32_bf16 v24, s45, v174
    v_dot2c_f32_bf16 v24, s45, v175
    s_waitcnt lgkmcnt(5)
    v_dot2c_f32_bf16 v25, s45, v176
    v_dot2c_f32_bf16 v25, s45, v177
    s_waitcnt lgkmcnt(4)
    v_dot2c_f32_bf16 v25, s45, v178
    v_dot2c_f32_bf16 v25, s45, v179
    s_waitcnt vmcnt(8)
    s_barrier
    v_mfma_f32_32x32x16_bf16 v[212:227], v[108:111], v[148:151], v[212:227]
    ds_read_b128 v[116:119], v16 offset:4096
    ds_read_b64_tr_b16 v[164:165], v20 offset:40960
    ds_read_b64_tr_b16 v[166:167], v20 offset:41472
    ds_read_b64_tr_b16 v[168:169], v21 offset:40960
    ds_read_b64_tr_b16 v[170:171], v21 offset:41472
    v_mfma_f32_32x32x16_bf16 v[228:243], v[108:111], v[152:155], v[228:243]
    s_lshl_b32 s51, s2, 2
    s_add_u32 s51, s51, s44
    s_lshl_b32 s51, s51, 9
    s_mov_b64 exec, 0xf
    buffer_load_dword v244, v251, s[16:19], s51 offen
    s_lshl_b32 s51, s51, 2
    s_mov_b64 exec, 0xffff
    buffer_load_dword v244, v251, s[28:31], s51 offen
    s_mov_b64 exec, -1
    s_lshr_b32 m0, s57, 1
    s_mul_i32 s51, s62, 1344
    s_add_u32 m0, m0, 77824
    s_nop 0
    buffer_load_dwordx4 v15, s[12:15], s51 offen lds
    s_waitcnt lgkmcnt(7)
    v_mfma_f32_32x32x16_bf16 v[212:227], v[112:115], v[156:159], v[212:227]
    ds_read_b128 v[120:123], v17 offset:4096
    ds_read_b64_tr_b16 v[148:149], v20 offset:43008
    s_waitcnt lgkmcnt(7)
    v_mfma_f32_32x32x16_bf16 v[228:243], v[112:115], v[160:163], v[228:243]
    ds_read_b64_tr_b16 v[150:151], v20 offset:43520
    ds_read_b64_tr_b16 v[152:153], v21 offset:43008
    ds_read_b64_tr_b16 v[154:155], v21 offset:43520
    s_waitcnt lgkmcnt(7)
    v_mfma_f32_32x32x16_bf16 v[212:227], v[116:119], v[164:167], v[212:227]
    ds_read_b128 v[124:127], v18 offset:4096
    ds_read_b128 v[128:131], v19 offset:4096
    ds_read_b64_tr_b16 v[172:173], v22 offset:40960
    s_waitcnt lgkmcnt(8)
    v_mfma_f32_32x32x16_bf16 v[228:243], v[116:119], v[168:171], v[228:243]
    ds_read_b64_tr_b16 v[174:175], v22 offset:41472
    ds_read_b64_tr_b16 v[156:157], v20 offset:45056
    ds_read_b64_tr_b16 v[158:159], v20 offset:45568
    ds_read_b64_tr_b16 v[160:161], v21 offset:45056
    ds_read_b64_tr_b16 v[162:163], v21 offset:45568
    s_waitcnt lgkmcnt(10)
    v_mfma_f32_32x32x16_bf16 v[212:227], v[120:123], v[148:151], v[212:227]
    ds_read_b64_tr_b16 v[176:177], v23 offset:40960
    ds_read_b64_tr_b16 v[178:179], v23 offset:41472
    ds_read_b64_tr_b16 v[164:165], v20 offset:47104
    s_waitcnt lgkmcnt(11)
    v_mfma_f32_32x32x16_bf16 v[228:243], v[120:123], v[152:155], v[228:243]
    ds_read_b64_tr_b16 v[166:167], v20 offset:47616
    ds_read_b64_tr_b16 v[168:169], v21 offset:47104
    ds_read_b64_tr_b16 v[170:171], v21 offset:47616
    v_dot2c_f32_bf16 v8, s45, v116
    v_dot2c_f32_bf16 v9, v116, v116
    v_dot2c_f32_bf16 v8, s45, v117
    v_dot2c_f32_bf16 v9, v117, v117
    v_dot2c_f32_bf16 v8, s45, v118
    v_dot2c_f32_bf16 v9, v118, v118
    v_dot2c_f32_bf16 v8, s45, v119
    v_dot2c_f32_bf16 v9, v119, v119
    v_dot2c_f32_bf16 v8, s45, v120
    v_dot2c_f32_bf16 v9, v120, v120
    v_dot2c_f32_bf16 v8, s45, v121
    v_dot2c_f32_bf16 v9, v121, v121
    v_dot2c_f32_bf16 v8, s45, v122
    v_dot2c_f32_bf16 v9, v122, v122
    v_dot2c_f32_bf16 v8, s45, v123
    v_dot2c_f32_bf16 v9, v123, v123
    s_waitcnt lgkmcnt(13)
    v_dot2c_f32_bf16 v8, s45, v124
    v_dot2c_f32_bf16 v9, v124, v124
    v_dot2c_f32_bf16 v8, s45, v125
    v_dot2c_f32_bf16 v9, v125, v125
    v_dot2c_f32_bf16 v8, s45, v126
    v_dot2c_f32_bf16 v9, v126, v126
    v_dot2c_f32_bf16 v8, s45, v127
    v_dot2c_f32_bf16 v9, v127, v127
    s_waitcnt lgkmcnt(12)
    v_dot2c_f32_bf16 v8, s45, v128
    v_dot2c_f32_bf16 v9, v128, v128
    v_dot2c_f32_bf16 v8, s45, v129
    v_dot2c_f32_bf16 v9, v129, v129
    v_dot2c_f32_bf16 v8, s45, v130
    v_dot2c_f32_bf16 v9, v130, v130
    v_dot2c_f32_bf16 v8, s45, v131
    v_dot2c_f32_bf16 v9, v131, v131
    s_waitcnt lgkmcnt(11)
    v_dot2c_f32_bf16 v24, s45, v172
    v_dot2c_f32_bf16 v24, s45, v173
    s_waitcnt lgkmcnt(10)
    v_dot2c_f32_bf16 v24, s45, v174
    v_dot2c_f32_bf16 v24, s45, v175
    s_waitcnt lgkmcnt(5)
    v_dot2c_f32_bf16 v25, s45, v176
    v_dot2c_f32_bf16 v25, s45, v177
    s_waitcnt lgkmcnt(4)
    v_dot2c_f32_bf16 v25, s45, v178
    v_dot2c_f32_bf16 v25, s45, v179
    s_waitcnt vmcnt(4)
    s_barrier
    v_mfma_f32_32x32x16_bf16 v[212:227], v[124:127], v[156:159], v[212:227]
    ds_read_b128 v[132:135], v16 offset:8192
    ds_read_b128 v[136:139], v17 offset:8192
    ds_read_b64_tr_b16 v[148:149], v20 offset:49152
    ds_read_b64_tr_b16 v[150:151], v20 offset:49664
    ds_read_b64_tr_b16 v[152:153], v21 offset:49152
    ds_read_b64_tr_b16 v[154:155], v21 offset:49664
    v_mfma_f32_32x32x16_bf16 v[228:243], v[124:127], v[160:163], v[228:243]
    v_mov_b32 v3, s45
    s_mov_b64 exec, 0xf
    v_lshlrev_b32 v32, 2, v1
    buffer_store_dword v3, v32, s[40:43], s50 offen sc1
    s_mov_b64 exec, -1
    s_lshr_b32 m0, s57, 1
    s_mul_i32 s51, s63, 1344
    s_add_u32 m0, m0, 81920
    s_nop 0
    buffer_load_dwordx4 v15, s[12:15], s51 offen lds
    s_waitcnt lgkmcnt(8)
    v_mfma_f32_32x32x16_bf16 v[212:227], v[128:131], v[164:167], v[212:227]
    ds_read_b128 v[140:143], v18 offset:8192
    ds_read_b128 v[144:147], v19 offset:8192
    ds_read_b64_tr_b16 v[172:173], v22 offset:49152
    ds_read_b64_tr_b16 v[174:175], v22 offset:49664
    s_waitcnt lgkmcnt(10)
    v_mfma_f32_32x32x16_bf16 v[228:243], v[128:131], v[168:171], v[228:243]
    ds_read_b64_tr_b16 v[176:177], v23 offset:49152
    ds_read_b64_tr_b16 v[178:179], v23 offset:49664
    ds_read_b64_tr_b16 v[156:157], v20 offset:51200
    ds_read_b64_tr_b16 v[158:159], v20 offset:51712
    ds_read_b64_tr_b16 v[160:161], v21 offset:51200
    ds_read_b64_tr_b16 v[162:163], v21 offset:51712
    s_waitcnt lgkmcnt(12)
    v_mfma_f32_32x32x16_bf16 v[212:227], v[132:135], v[148:151], v[212:227]
    ds_read_b64_tr_b16 v[164:165], v20 offset:53248
    ds_read_b64_tr_b16 v[166:167], v20 offset:53760
    s_waitcnt lgkmcnt(12)
    v_mfma_f32_32x32x16_bf16 v[228:243], v[132:135], v[152:155], v[228:243]
    ds_read_b64_tr_b16 v[168:169], v21 offset:53248
    ds_read_b64_tr_b16 v[170:171], v21 offset:53760
    v_dot2c_f32_bf16 v8, s45, v132
    v_dot2c_f32_bf16 v9, v132, v132
    v_dot2c_f32_bf16 v8, s45, v133
    v_dot2c_f32_bf16 v9, v133, v133
    v_dot2c_f32_bf16 v8, s45, v134
    v_dot2c_f32_bf16 v9, v134, v134
    v_dot2c_f32_bf16 v8, s45, v135
    v_dot2c_f32_bf16 v9, v135, v135
    v_dot2c_f32_bf16 v8, s45, v136
    v_dot2c_f32_bf16 v9, v136, v136
    v_dot2c_f32_bf16 v8, s45, v137
    v_dot2c_f32_bf16 v9, v137, v137
    v_dot2c_f32_bf16 v8, s45, v138
    v_dot2c_f32_bf16 v9, v138, v138
    v_dot2c_f32_bf16 v8, s45, v139
    v_dot2c_f32_bf16 v9, v139, v139
    s_waitcnt lgkmcnt(13)
    v_dot2c_f32_bf16 v8, s45, v140
    v_dot2c_f32_bf16 v9, v140, v140
    v_dot2c_f32_bf16 v8, s45, v141
    v_dot2c_f32_bf16 v9, v141, v141
    v_dot2c_f32_bf16 v8, s45, v142
    v_dot2c_f32_bf16 v9, v142, v142
    v_dot2c_f32_bf16 v8, s45, v143
    v_dot2c_f32_bf16 v9, v143, v143
    s_waitcnt lgkmcnt(12)
    v_dot2c_f32_bf16 v8, s45, v144
    v_dot2c_f32_bf16 v9, v144, v144
    v_dot2c_f32_bf16 v8, s45, v145
    v_dot2c_f32_bf16 v9, v145, v145
    v_dot2c_f32_bf16 v8, s45, v146
    v_dot2c_f32_bf16 v9, v146, v146
    v_dot2c_f32_bf16 v8, s45, v147
    v_dot2c_f32_bf16 v9, v147, v147
    s_waitcnt lgkmcnt(11)
    v_dot2c_f32_bf16 v24, s45, v172
    v_dot2c_f32_bf16 v24, s45, v173
    s_waitcnt lgkmcnt(10)
    v_dot2c_f32_bf16 v24, s45, v174
    v_dot2c_f32_bf16 v24, s45, v175
    s_waitcnt lgkmcnt(9)
    v_dot2c_f32_bf16 v25, s45, v176
    v_dot2c_f32_bf16 v25, s45, v177
    s_waitcnt lgkmcnt(8)
    v_dot2c_f32_bf16 v25, s45, v178
    v_dot2c_f32_bf16 v25, s45, v179
    s_waitcnt lgkmcnt(6)
    v_mfma_f32_32x32x16_bf16 v[212:227], v[136:139], v[156:159], v[212:227]
    ds_read_b64_tr_b16 v[148:149], v20 offset:55296
    ds_read_b64_tr_b16 v[150:151], v20 offset:55808
    ds_read_b64_tr_b16 v[152:153], v21 offset:55296
    ds_read_b64_tr_b16 v[154:155], v21 offset:55808
    v_mov_b32 v5, v24
    s_waitcnt lgkmcnt(8)
    v_mfma_f32_32x32x16_bf16 v[228:243], v[136:139], v[160:163], v[228:243]
    v_permlane32_swap_b32 v5, v24
    v_add_f32 v24, v24, v5
    v_mov_b32 v5, v25
    s_nop 1
    v_permlane32_swap_b32 v5, v25
    v_add_f32 v25, v25, v5
    ds_write_b32 v28, v24 offset:0
    ds_write_b32 v28, v25 offset:512
    s_waitcnt lgkmcnt(8)
    v_mfma_f32_32x32x16_bf16 v[212:227], v[140:143], v[164:167], v[212:227]
    v_mov_b32 v4, v8
    s_nop 1
    v_permlane32_swap_b32 v4, v8
    v_add_f32 v8, v8, v4
    v_mov_b32 v5, v9
    s_nop 1
    v_permlane32_swap_b32 v5, v9
    v_add_f32 v9, v9, v5
    s_waitcnt lgkmcnt(0)
    s_barrier
    v_mfma_f32_32x32x16_bf16 v[228:243], v[140:143], v[168:171], v[228:243]
    ds_read_b128 v[172:175], v27 offset:0
    ds_read_b128 v[176:179], v27 offset:512
    v_mfma_f32_32x32x16_bf16 v[212:227], v[144:147], v[148:151], v[212:227]
    v_mul_f32 v32, 0xbb124925, v8
    v_mul_f32 v9, 0x3b124925, v9
    v_fma_f32 v9, -v32, v32, v9
    v_max_f32 v9, 0, v9
    v_add_f32 v9, 0x3727c5ac, v9
    v_rsq_f32 v33, v9
    s_nop 0
    ds_write_b32 v29, v33
    ds_read_b128 v[196:199], v30 offset:0
    ds_read_b128 v[200:203], v30 offset:32
    v_mfma_f32_32x32x16_bf16 v[228:243], v[144:147], v[152:155], v[228:243]
    ds_read_b128 v[204:207], v30 offset:64
    ds_read_b128 v[208:211], v30 offset:96
    v_cvt_pk_bf16_f32 v180, v32, v32
    v_and_b32 v4, 0xffff0000, v180
    v_sub_f32 v4, v32, v4
    v_cvt_pk_bf16_f32 v4, v4, v4
    v_cndmask_b32 v180, v180, v4, vcc
    v_mov_b32 v32, v33
    s_waitcnt lgkmcnt(6)
    v_add_f32 v172, v172, v173
    v_add_f32 v174, v174, v175
    v_add_f32 v172, v172, v174
    v_cvt_pk_bf16_f32 v4, v172, v172
    v_and_b32 v4, 0xffff0000, v4
    v_sub_f32 v4, v172, v4
    v_cvt_pk_bf16_f32 v184, v172, v4
    s_nop 1
    v_mfma_f32_32x32x16_bf16 v[212:227], v[180:183], v[184:187], v[212:227]
    s_waitcnt lgkmcnt(5)
    v_add_f32 v176, v176, v177
    v_add_f32 v178, v178, v179
    v_add_f32 v176, v176, v178
    v_cvt_pk_bf16_f32 v4, v176, v176
    v_and_b32 v4, 0xffff0000, v4
    v_sub_f32 v4, v176, v4
    v_cvt_pk_bf16_f32 v188, v176, v4
    s_nop 1
    v_mfma_f32_32x32x16_bf16 v[228:243], v[180:183], v[188:191], v[228:243]
    s_waitcnt lgkmcnt(3)
    v_pk_mul_f32 v[212:213], v[212:213], v[196:197]
    v_pk_mul_f32 v[214:215], v[214:215], v[198:199]
    s_waitcnt lgkmcnt(2)
    v_pk_mul_f32 v[216:217], v[216:217], v[200:201]
    v_pk_mul_f32 v[218:219], v[218:219], v[202:203]
    v_cvt_pk_bf16_f32 v212, v212, v213
    v_cvt_pk_bf16_f32 v213, v214, v215
    v_cvt_pk_bf16_f32 v214, v216, v217
    v_cvt_pk_bf16_f32 v215, v218, v219
    buffer_store_dwordx4 v[212:215], v31, s[40:43], s48 offen offset:0 sc1
    s_waitcnt lgkmcnt(1)
    v_pk_mul_f32 v[220:221], v[220:221], v[204:205]
    v_pk_mul_f32 v[222:223], v[222:223], v[206:207]
    s_waitcnt lgkmcnt(0)
    v_pk_mul_f32 v[224:225], v[224:225], v[208:209]
    v_pk_mul_f32 v[226:227], v[226:227], v[210:211]
    v_cvt_pk_bf16_f32 v220, v220, v221
    v_cvt_pk_bf16_f32 v221, v222, v223
    v_cvt_pk_bf16_f32 v222, v224, v225
    v_cvt_pk_bf16_f32 v223, v226, v227
    buffer_store_dwordx4 v[220:223], v31, s[40:43], s49 offen offset:0 sc1
    v_pk_mul_f32 v[228:229], v[228:229], v[196:197]
    v_pk_mul_f32 v[230:231], v[230:231], v[198:199]
    v_pk_mul_f32 v[232:233], v[232:233], v[200:201]
    v_pk_mul_f32 v[234:235], v[234:235], v[202:203]
    v_cvt_pk_bf16_f32 v228, v228, v229
    v_cvt_pk_bf16_f32 v229, v230, v231
    v_cvt_pk_bf16_f32 v230, v232, v233
    v_cvt_pk_bf16_f32 v231, v234, v235
    buffer_store_dwordx4 v[228:231], v31, s[40:43], s48 offen offset:512 sc1
    v_pk_mul_f32 v[236:237], v[236:237], v[204:205]
    v_pk_mul_f32 v[238:239], v[238:239], v[206:207]
    v_pk_mul_f32 v[240:241], v[240:241], v[208:209]
    v_pk_mul_f32 v[242:243], v[242:243], v[210:211]
    v_cvt_pk_bf16_f32 v236, v236, v237
    v_cvt_pk_bf16_f32 v237, v238, v239
    v_cvt_pk_bf16_f32 v238, v240, v241
    v_cvt_pk_bf16_f32 v239, v242, v243
    buffer_store_dwordx4 v[236:239], v31, s[40:43], s49 offen offset:512 sc1
    s_waitcnt vmcnt(4)
    s_branch L_p1_done
L_aux:
    s_waitcnt vmcnt(0)
    s_cmp_ge_u32 s52, 28
    s_cbranch_scc1 L_p1_done
    s_cmp_lg_u32 s44, 0
    s_cbranch_scc1 L_p1_done
    v_mov_b32 v185, v196
    v_mov_b32 v189, v197
    s_lshl_b32 s48, s52, 11
    s_add_u32 s48, s48, 10616832
    buffer_store_dwordx4 v[184:187], v2, s[40:43], s48 offen sc1
    buffer_store_dwordx4 v[188:191], v2, s[40:43], s48 offen offset:1024 sc1
L_p1_done:
    s_waitcnt lgkmcnt(0)
    s_barrier
    ds_read_b64_tr_b16 a[128:129], v14 offset:0
    ds_read_b64_tr_b16 a[130:131], v14 offset:256
    ds_read_b64_tr_b16 a[132:133], v14 offset:1024
    ds_read_b64_tr_b16 a[134:135], v14 offset:1280
    ds_read_b64_tr_b16 a[136:137], v14 offset:2048
    ds_read_b64_tr_b16 a[138:139], v14 offset:2304
    ds_read_b64_tr_b16 a[140:141], v14 offset:3072
    ds_read_b64_tr_b16 a[142:143], v14 offset:3328
    v_mov_b32 v164, s45
    v_mov_b32 v165, s45
    v_mov_b32 v166, s45
    v_mov_b32 v167, s45
    s_waitcnt lgkmcnt(6)
    s_nop 0
    v_mfma_f32_32x32x16_bf16 v[216:231], v[164:167], a[128:131], 0
    ds_read_b64_tr_b16 a[144:145], v14 offset:4096
    ds_read_b64_tr_b16 a[146:147], v14 offset:4352
    s_mov_b32 s56, s47
    s_mov_b32 s57, s46
    s_lshl_b32 s3, s46, 4
    s_add_u32 s3, s3, s47
    v_mfma_f32_32x32x16_bf16 v[148:163], a[128:131], v[36:39], 0
    s_lshl_b32 s3, s3, 7
    s_add_u32 s3, s3, 18874368
    s_mul_i32 s101, s101, 0x41c64e6d
    s_add_u32 s101, s101, 0x3039f4a7
    s_getreg_b32 s96, hwreg(HW_REG_XCC_ID)
    s_and_b32 s96, s96, 15
    v_mov_b32 v254, s101
    v_mov_b32 v255, s96
    s_waitcnt lgkmcnt(6)
    v_mfma_f32_32x32x16_bf16 v[216:231], v[164:167], a[132:135], v[216:231]
    ds_read_b64_tr_b16 a[148:149], v14 offset:5120
    ds_read_b64_tr_b16 a[150:151], v14 offset:5376
    s_and_b32 s48, s2, 7
    s_lshl_b32 s48, s48, 1
    s_bfe_u32 s49, s2, 0x10003
    s_add_u32 s46, s48, s49
    v_mfma_f32_32x32x16_bf16 v[148:163], a[132:135], v[40:43], v[148:163]
    s_lshr_b32 s47, s2, 4
    s_lshl_b32 s97, s46, 11
    s_add_u32 s97, s97, 18907136
    s_cmp_ge_u32 s47, 7
    s_cselect_b32 s49, 2, 0
    s_cselect_b32 s48, 7, 0
    s_sub_u32 s60, s47, s48
    s_lshl_b32 s61, s46, 2
    s_waitcnt lgkmcnt(6)
    v_mfma_f32_32x32x16_bf16 v[216:231], v[164:167], a[136:139], v[216:231]
    ds_read_b64_tr_b16 a[128:129], v14 offset:6144
    ds_read_b64_tr_b16 a[130:131], v14 offset:6400
    s_add_u32 s61, s61, s49
    s_lshr_b32 s48, s44, 1
    s_add_u32 s62, s61, s48
    s_and_b32 s55, s44, 1
    v_mfma_f32_32x32x16_bf16 v[148:163], a[136:139], v[44:47], v[148:163]
    s_lshl_b32 s63, s60, 1
    s_add_u32 s63, s63, s55
    s_mul_i32 s58, s44, 12288
    s_add_u32 s58, s58, 114688
    s_mul_i32 s59, s44, 14336
    s_mul_i32 s53, s44, 100352
    s_lshl_b32 s48, s60, 7
    s_add_u32 s100, s53, s53
    s_waitcnt lgkmcnt(6)
    v_mfma_f32_32x32x16_bf16 v[216:231], v[164:167], a[140:143], v[216:231]
    ds_read_b64_tr_b16 a[132:133], v14 offset:7168
    ds_read_b64_tr_b16 a[134:135], v14 offset:7424
    s_add_u32 s53, s53, s48
    s_add_u32 s100, s100, s48
    s_mul_i32 s99, s44, 401408
    s_lshl_b32 s48, s47, 7
    v_mfma_f32_32x32x16_bf16 v[148:163], a[140:143], v[48:51], v[148:163]
    s_add_u32 s99, s99, s48
    v_lshrrev_b32 v3, 3, v1
    v_mul_u32_u24 v188, 3584, v3
    v_bfe_u32 v3, v1, 4, 1
    v_lshlrev_b32 v3, 2, v3
    v_and_b32 v4, 7, v1
    v_xor_b32 v3, v3, v4
    v_lshl_add_u32 v188, v3, 4, v188
    s_waitcnt lgkmcnt(6)
    v_mfma_f32_32x32x16_bf16 v[216:231], v[164:167], a[144:147], v[216:231]
    ds_read_b64_tr_b16 a[136:137], v14 offset:8192
    ds_read_b64_tr_b16 a[138:139], v14 offset:8448
    v_lshrrev_b32 v3, 3, v1
    v_mul_u32_u24 v184, 896, v3
    v_bfe_u32 v3, v1, 4, 1
    v_lshlrev_b32 v3, 2, v3
    v_mfma_f32_32x32x16_bf16 v[148:163], a[144:147], v[52:55], v[148:163]
    v_and_b32 v4, 7, v1
    v_xor_b32 v3, v3, v4
    v_lshl_add_u32 v184, v3, 4, v184
    v_add_u32 v189, 27648, v188
    v_add_u32 v185, 6144, v184
    v_add_u32 v190, 55296, v188
    v_add_u32 v186, 12288, v184
    v_add_u32 v191, 82944, v188
    s_waitcnt lgkmcnt(6)
    v_mfma_f32_32x32x16_bf16 v[216:231], v[164:167], a[148:151], v[216:231]
    ds_read_b64_tr_b16 a[140:141], v14 offset:9216
    ds_read_b64_tr_b16 a[142:143], v14 offset:9472
    v_add_u32 v187, 18432, v184
    s_mul_i32 s48, s56, 7
    s_lshr_b32 s48, s48, 1
    s_lshr_b32 s12, s48, 3
    v_mfma_f32_32x32x16_bf16 v[148:163], a[148:151], v[56:59], v[148:163]
    s_add_u32 s13, s48, 3
    s_lshr_b32 s13, s13, 3
    s_lshl_b32 s98, s48, 9
    s_mul_i32 s48, s56, 28
    s_lshr_b32 s49, s48, 6
    s_add_u32 s14, s49, 7
    s_add_u32 s15, s48, 475
    s_lshr_b32 s15, s15, 6
    s_waitcnt lgkmcnt(6)
    v_mfma_f32_32x32x16_bf16 v[216:231], v[164:167], a[128:131], v[216:231]
    ds_read_b64_tr_b16 a[144:145], v14 offset:10240
    ds_read_b64_tr_b16 a[146:147], v14 offset:10496
    v_and_b32 v3, 3, v1
    v_mov_b32 v250, s12
    v_mov_b32 v4, s13
    v_cmp_eq_u32 vcc, 1, v3
    v_mfma_f32_32x32x16_bf16 v[148:163], a[128:131], v[60:63], v[148:163]
    s_nop 0
    v_cndmask_b32 v250, v250, v4, vcc
    v_mov_b32 v4, s14
    v_cmp_eq_u32 vcc, 2, v3
    s_nop 1
    v_cndmask_b32 v250, v250, v4, vcc
    v_mov_b32 v4, s15
    v_cmp_eq_u32 vcc, 3, v3
    s_nop 1
    v_cndmask_b32 v250, v250, v4, vcc
    v_bfe_u32 v3, v1, 2, 2
    s_waitcnt lgkmcnt(6)
    v_mfma_f32_32x32x16_bf16 v[216:231], v[164:167], a[132:135], v[216:231]
    ds_read_b64_tr_b16 a[148:149], v14 offset:11264
    ds_read_b64_tr_b16 a[150:151], v14 offset:11520
    s_lshl_b32 s50, s44, 2
    v_add_u32 v3, s50, v3
    v_lshl_add_u32 v250, v3, 4, v250
    v_lshlrev_b32 v250, 7, v250
    v_mfma_f32_32x32x16_bf16 v[148:163], a[132:135], v[64:67], v[148:163]
    v_add_u32 v250, 18874368, v250
    v_lshrrev_b32 v3, 5, v1
    v_mul_u32_u24 v7, 6656, v3
    s_lshl_b32 s48, s48, 4
    s_add_u32 s48, s48, 28672
    v_add3_u32 v7, v7, v2, s48
    v_add_u32 v8, 14336, v7
    s_lshl_b32 s49, s49, 4
    s_waitcnt lgkmcnt(6)
    v_mfma_f32_32x32x16_bf16 v[216:231], v[164:167], a[136:139], v[216:231]
    ds_read_b64_tr_b16 a[128:129], v14 offset:12288
    ds_read_b64_tr_b16 a[130:131], v14 offset:12544
    s_add_u32 s49, s49, 57344
    v_mov_b32 v4, s49
    v_and_b32 v3, 31, v1
    v_cmp_lt_u32 vcc, 27, v3
    v_mfma_f32_32x32x16_bf16 v[148:163], a[136:139], v[68:71], v[148:163]
    s_nop 0
    v_cndmask_b32 v7, v7, v4, vcc
    v_cndmask_b32 v8, v8, v4, vcc
    v_mov_b32 v4, 0x70000000
    v_cmp_lt_u32 vcc, 28, v3
    s_nop 1
    v_cndmask_b32 v7, v7, v4, vcc
    v_cndmask_b32 v8, v8, v4, vcc
    v_and_b32 v9, 51, v1
    v_bfe_u32 v4, v1, 2, 1
    s_waitcnt lgkmcnt(6)
    v_mfma_f32_32x32x16_bf16 v[216:231], v[164:167], a[140:143], v[216:231]
    ds_read_b64_tr_b16 a[132:133], v14 offset:13312
    ds_read_b64_tr_b16 a[134:135], v14 offset:13568
    v_lshl_add_u32 v9, v4, 3, v9
    v_bfe_u32 v4, v1, 3, 1
    v_lshl_add_u32 v9, v4, 2, v9
    v_lshl_add_u32 v9, v9, 4, s98
    v_mfma_f32_32x32x16_bf16 v[148:163], a[140:143], v[72:75], v[148:163]
    v_mov_b32 v11, 0xdddddddd
    s_mul_i32 s52, s44, 919552
    v_mul_u32_u24 v212, 896, v3
    v_lshrrev_b32 v3, 5, v1
    v_lshlrev_b32 v213, 4, v3
    v_add_u32 v212, v213, v212
    s_mul_i32 s48, s62, 28672
    s_lshl_b32 s50, s63, 6
    s_waitcnt lgkmcnt(6)
    v_mfma_f32_32x32x16_bf16 v[216:231], v[164:167], a[144:147], v[216:231]
    ds_read_b64_tr_b16 a[136:137], v14 offset:14336
    ds_read_b64_tr_b16 a[138:139], v14 offset:14592
    s_add_u32 s48, s48, s50
    v_add_u32 v212, s48, v212
    v_add_u32 v213, s50, v213
    v_min_u32 v214, 13, v1
    v_mfma_f32_32x32x16_bf16 v[148:163], a[144:147], v[76:79], v[148:163]
    v_lshlrev_b32 v214, 7, v214
    s_mov_b32 s24, s40
    s_mov_b32 s25, s41
    s_mov_b32 s26, 0
    s_mov_b32 s27, 0x00020000
    s_mov_b32 s4, s40
    s_mov_b32 s5, s41
    s_mov_b32 s6, 0
    s_waitcnt lgkmcnt(6)
    v_mfma_f32_32x32x16_bf16 v[216:231], v[164:167], a[148:151], v[216:231]
    ds_read_b64_tr_b16 a[140:141], v14 offset:15360
    ds_read_b64_tr_b16 a[142:143], v14 offset:15616
    s_mov_b32 s7, 0x00020000
    s_and_b32 s48, s56, 1
    s_cmp_eq_u32 s48, 1
    s_cselect_b32 s48, 0, -1
    v_mfma_f32_32x32x16_bf16 v[148:163], a[148:151], v[80:83], v[148:163]
    s_cselect_b32 s49, -1, 0
    v_cmp_lt_u32 vcc, 31, v1
    v_mov_b32 v3, s48
    v_mov_b32 v4, s49
    v_cndmask_b32 v5, v3, -1, vcc
    v_cndmask_b32 v6, -1, v4, vcc
    s_lshl_b32 s48, s57, 2
    s_add_u32 s48, s48, s44
    s_waitcnt lgkmcnt(6)
    v_mfma_f32_32x32x16_bf16 v[216:231], v[164:167], a[128:131], v[216:231]
    ds_read_b64_tr_b16 a[144:145], v14 offset:16384
    ds_read_b64_tr_b16 a[146:147], v14 offset:16640
    s_lshl_b32 s48, s48, 4
    s_add_u32 s48, s48, s56
    s_lshl_b32 s49, s62, 4
    s_add_u32 s49, s49, s63
    v_mfma_f32_32x32x16_bf16 v[148:163], a[128:131], v[84:87], v[148:163]
    s_lshl_b32 s50, s46, 2
    s_add_u32 s50, s50, s44
    s_lshl_b32 s50, s50, 4
    s_add_u32 s50, s50, s47
    v_mov_b32 v3, s50
    v_writelane_b32 v3, s48, 0
    v_writelane_b32 v3, s49, 1
    v_lshl_add_u32 v3, v1, 10, v3
    s_waitcnt lgkmcnt(6)
    v_mfma_f32_32x32x16_bf16 v[216:231], v[164:167], a[132:135], v[216:231]
    ds_read_b64_tr_b16 a[148:149], v14 offset:17408
    ds_read_b64_tr_b16 a[150:151], v14 offset:17664
    v_mfma_f32_32x32x16_bf16 v[148:163], a[132:135], v[88:91], v[148:163]
    v_lshlrev_b32 v3, 7, v3
    s_mov_b32 s48, 18350080
    s_lshl_b32 s49, s47, 7
    s_add_u32 s49, s49, s97
    s_waitcnt vmcnt(0)
    s_barrier
    s_cmp_lg_u32 s44, 0
    s_cbranch_scc1 L_noflagA
    s_mov_b64 exec, 1
    buffer_store_dword v254, v10, s[40:43], s3 offen sc1
    s_mov_b64 exec, -1
L_noflagA:
    s_waitcnt lgkmcnt(6)
    v_mfma_f32_32x32x16_bf16 v[216:231], v[164:167], a[136:139], v[216:231]
    ds_read_b64_tr_b16 a[128:129], v14 offset:18432
    ds_read_b64_tr_b16 a[130:131], v14 offset:18688
    v_mfma_f32_32x32x16_bf16 v[148:163], a[136:139], v[92:95], v[148:163]
    s_mov_b64 exec, 15
    buffer_load_dword v244, v3, s[40:43], s48 offen
    s_mov_b64 exec, 1
    buffer_store_dwordx2 v[254:255], v10, s[40:43], s49 offen sc1
    s_mov_b64 exec, -1
    v_mov_b32 v196, 0
    s_waitcnt lgkmcnt(6)
    v_mfma_f32_32x32x16_bf16 v[216:231], v[164:167], a[140:143], v[216:231]
    ds_read_b64_tr_b16 a[132:133], v14 offset:19456
    ds_read_b64_tr_b16 a[134:135], v14 offset:19712
    v_mfma_f32_32x32x16_bf16 v[148:163], a[140:143], v[96:99], v[148:163]
    v_mov_b32 v197, 0
    v_mov_b32 v198, 0
    s_waitcnt lgkmcnt(6)
    v_mfma_f32_32x32x16_bf16 v[216:231], v[164:167], a[144:147], v[216:231]
    ds_read_b64_tr_b16 a[136:137], v14 offset:20480
    ds_read_b64_tr_b16 a[138:139], v14 offset:20736
    v_mfma_f32_32x32x16_bf16 v[148:163], a[144:147], v[100:103], v[148:163]
    v_mov_b32 v199, 0
    v_mov_b32 v200, 0
    s_waitcnt lgkmcnt(6)
    v_mfma_f32_32x32x16_bf16 v[216:231], v[164:167], a[148:151], v[216:231]
    ds_read_b64_tr_b16 a[140:141], v14 offset:21504
    ds_read_b64_tr_b16 a[142:143], v14 offset:21760
    v_mfma_f32_32x32x16_bf16 v[148:163], a[148:151], v[104:107], v[148:163]
    v_mov_b32 v201, 0
    v_mov_b32 v202, 0
    s_waitcnt lgkmcnt(6)
    v_mfma_f32_32x32x16_bf16 v[216:231], v[164:167], a[128:131], v[216:231]
    ds_read_b64_tr_b16 a[144:145], v14 offset:22528
    ds_read_b64_tr_b16 a[146:147], v14 offset:22784
    v_mfma_f32_32x32x16_bf16 v[148:163], a[128:131], v[108:111], v[148:163]
    v_mov_b32 v203, 0
    v_mov_b32 v204, 0
    s_waitcnt lgkmcnt(6)
    v_mfma_f32_32x32x16_bf16 v[216:231], v[164:167], a[132:135], v[216:231]
    ds_read_b64_tr_b16 a[148:149], v14 offset:23552
    ds_read_b64_tr_b16 a[150:151], v14 offset:23808
    v_mfma_f32_32x32x16_bf16 v[148:163], a[132:135], v[112:115], v[148:163]
    v_mov_b32 v205, 0
    v_mov_b32 v206, 0
    s_waitcnt lgkmcnt(6)
    v_mfma_f32_32x32x16_bf16 v[216:231], v[164:167], a[136:139], v[216:231]
    ds_read_b64_tr_b16 a[128:129], v14 offset:24576
    ds_read_b64_tr_b16 a[130:131], v14 offset:24832
    v_mfma_f32_32x32x16_bf16 v[148:163], a[136:139], v[116:119], v[148:163]
    v_mov_b32 v207, 0
    v_mov_b32 v208, 0
    s_waitcnt lgkmcnt(6)
    v_mfma_f32_32x32x16_bf16 v[216:231], v[164:167], a[140:143], v[216:231]
    ds_read_b64_tr_b16 a[132:133], v14 offset:25600
    ds_read_b64_tr_b16 a[134:135], v14 offset:25856
    v_mfma_f32_32x32x16_bf16 v[148:163], a[140:143], v[120:123], v[148:163]
    v_mov_b32 v209, 0
    v_mov_b32 v210, 0
    s_waitcnt lgkmcnt(6)
    v_mfma_f32_32x32x16_bf16 v[216:231], v[164:167], a[144:147], v[216:231]
    ds_read_b64_tr_b16 a[136:137], v14 offset:26624
    ds_read_b64_tr_b16 a[138:139], v14 offset:26880
    v_mfma_f32_32x32x16_bf16 v[148:163], a[144:147], v[124:127], v[148:163]
    v_mov_b32 v211, 0
    v_accvgpr_write_b32 a0, 0
    s_waitcnt lgkmcnt(6)
    v_mfma_f32_32x32x16_bf16 v[216:231], v[164:167], a[148:151], v[216:231]
    ds_read_b64_tr_b16 a[140:141], v14 offset:27648
    ds_read_b64_tr_b16 a[142:143], v14 offset:27904
    v_mfma_f32_32x32x16_bf16 v[148:163], a[148:151], v[128:131], v[148:163]
    v_accvgpr_write_b32 a1, 0
    v_accvgpr_write_b32 a2, 0
    s_waitcnt lgkmcnt(6)
    v_mfma_f32_32x32x16_bf16 v[216:231], v[164:167], a[128:131], v[216:231]
    v_accvgpr_write_b32 a3, 0
    v_mfma_f32_32x32x16_bf16 v[148:163], a[128:131], v[132:135], v[148:163]
    v_accvgpr_write_b32 a4, 0
    s_waitcnt lgkmcnt(4)
    v_mfma_f32_32x32x16_bf16 v[216:231], v[164:167], a[132:135], v[216:231]
    v_accvgpr_write_b32 a5, 0
    v_mfma_f32_32x32x16_bf16 v[148:163], a[132:135], v[136:139], v[148:163]
    v_accvgpr_write_b32 a6, 0
    s_waitcnt lgkmcnt(2)
    v_mfma_f32_32x32x16_bf16 v[216:231], v[164:167], a[136:139], v[216:231]
    v_accvgpr_write_b32 a7, 0
    v_mfma_f32_32x32x16_bf16 v[148:163], a[136:139], v[140:143], v[148:163]
    v_accvgpr_write_b32 a8, 0
    s_waitcnt lgkmcnt(0)
    v_mfma_f32_32x32x16_bf16 v[216:231], v[164:167], a[140:143], v[216:231]
    v_accvgpr_write_b32 a9, 0
    v_mfma_f32_32x32x16_bf16 v[148:163], a[140:143], v[144:147], v[148:163]
    v_accvgpr_write_b32 a10, 0
    v_accvgpr_write_b32 a11, 0
    v_accvgpr_write_b32 a12, 0
    v_accvgpr_write_b32 a13, 0
    v_accvgpr_write_b32 a14, 0
    v_accvgpr_write_b32 a15, 0
    v_accvgpr_write_b32 a16, 0
    v_accvgpr_write_b32 a17, 0
    v_accvgpr_write_b32 a18, 0
    v_accvgpr_write_b32 a19, 0
    v_accvgpr_write_b32 a20, 0
    v_accvgpr_write_b32 a21, 0
    v_accvgpr_write_b32 a22, 0
    v_cvt_pk_bf16_f32 v4, v216, v216
    v_and_b32 v4, 0xffff0000, v4
    v_sub_f32 v4, v216, v4
    v_cvt_pk_bf16_f32 v192, v216, v4
    s_nop 1
    v_mfma_f32_32x32x16_bf16 v[148:163], v[192:195], v[180:183], v[148:163]
    v_mul_f32 v32, 0x3e8b97f6, v33
    s_lshl_b32 s48, s44, 11
    s_add_u32 s48, s48, 153600
    v_add_u32 v3, s48, v2
    v_accvgpr_write_b32 a23, 0
    v_accvgpr_write_b32 a24, 0
    v_accvgpr_write_b32 a25, 0
    v_accvgpr_write_b32 a26, 0
    v_accvgpr_write_b32 a27, 0
    v_accvgpr_write_b32 a28, 0
    v_accvgpr_write_b32 a29, 0
    v_accvgpr_write_b32 a30, 0
    v_accvgpr_write_b32 a31, 0
    v_accvgpr_write_b32 a32, 0
    v_accvgpr_write_b32 a33, 0
    v_accvgpr_write_b32 a34, 0
    v_accvgpr_write_b32 a35, 0
    v_accvgpr_write_b32 a36, 0
    v_accvgpr_write_b32 a37, 0
    v_accvgpr_write_b32 a38, 0
    v_accvgpr_write_b32 a39, 0
    v_accvgpr_write_b32 a40, 0
    v_accvgpr_write_b32 a41, 0
    v_accvgpr_write_b32 a42, 0
    v_accvgpr_write_b32 a43, 0
    v_accvgpr_write_b32 a44, 0
    v_accvgpr_write_b32 a45, 0
    v_accvgpr_write_b32 a46, 0
    v_accvgpr_write_b32 a47, 0
    v_pk_mul_f32 v[148:149], v[148:149], v[32:33] op_sel_hi:[1,0]
    v_pk_mul_f32 v[150:151], v[150:151], v[32:33] op_sel_hi:[1,0]
    v_pk_mul_f32 v[152:153], v[152:153], v[32:33] op_sel_hi:[1,0]
    v_pk_mul_f32 v[154:155], v[154:155], v[32:33] op_sel_hi:[1,0]
    v_pk_mul_f32 v[156:157], v[156:157], v[32:33] op_sel_hi:[1,0]
    v_pk_mul_f32 v[158:159], v[158:159], v[32:33] op_sel_hi:[1,0]
    v_pk_mul_f32 v[160:161], v[160:161], v[32:33] op_sel_hi:[1,0]
    v_pk_mul_f32 v[162:163], v[162:163], v[32:33] op_sel_hi:[1,0]
    v_cvt_pk_bf16_f32 v12, v148, v149
    v_cvt_pk_bf16_f32 v13, v150, v151
    v_cvt_pk_bf16_f32 v14, v152, v153
    v_cvt_pk_bf16_f32 v15, v154, v155
    v_cvt_pk_bf16_f32 v16, v156, v157
    v_cvt_pk_bf16_f32 v17, v158, v159
    v_cvt_pk_bf16_f32 v18, v160, v161
    v_cvt_pk_bf16_f32 v19, v162, v163
    v_and_b32 v12, v5, v12
    v_and_b32 v13, v5, v13
    v_and_b32 v18, v6, v18
    v_and_b32 v19, v6, v19
    ds_write_b128 v3, v[12:15]
    ds_write_b128 v3, v[16:19] offset:1024
    buffer_load_dword v215, v250, s[40:43], 0 offen sc1
    s_xor_b32 s48, s44, 1
    s_mul_i32 s48, s48, 12288
    s_add_u32 s48, s48, 0
    v_add_u32 v192, s48, v2
    s_xor_b32 s48, s44, 2
    s_mul_i32 s48, s48, 12288
    s_add_u32 s48, s48, 4096
    v_add_u32 v193, s48, v2
    s_xor_b32 s48, s44, 3
    s_mul_i32 s48, s48, 12288
    s_add_u32 s48, s48, 8192
    v_add_u32 v194, s48, v2
    s_waitcnt lgkmcnt(0)
    s_barrier
    s_xor_b32 s48, s44, 1
    s_lshl_b32 s48, s48, 11
    s_add_u32 s48, s48, 153600
    v_add_u32 v3, s48, v2
    ds_read_b128 v[20:23], v3
    ds_read_b128 v[24:27], v3 offset:1024
    s_xor_b32 s48, s44, 2
    s_lshl_b32 s48, s48, 11
    s_add_u32 s48, s48, 153600
    v_add_u32 v3, s48, v2
    ds_read_b128 v[28:31], v3
    ds_read_b128 v[32:35], v3 offset:1024
    s_xor_b32 s48, s44, 3
    s_lshl_b32 s48, s48, 11
    s_add_u32 s48, s48, 153600
    v_add_u32 v3, s48, v2
    ds_read_b128 v[36:39], v3
    ds_read_b128 v[40:43], v3 offset:1024
    s_waitcnt vmcnt(0)
    v_cmp_ne_u32 vcc, s101, v215
    s_nop 0
    s_cbranch_vccz L_pollAok_1
    s_mov_b32 s54, 0x40000
L_pollA_2:
    buffer_load_dword v215, v250, s[40:43], 0 offen sc1
    s_sub_u32 s54, s54, 1
    s_waitcnt vmcnt(0)
    s_cbranch_scc1 L_pollA_2_x
    v_cmp_ne_u32 vcc, s101, v215
    s_nop 0
    s_cbranch_vccnz L_pollA_2
L_pollA_2_x:
L_pollAok_1:
    buffer_load_dwordx4 a[64:67], v9, s[40:43], s52 offen sc1
    buffer_load_dwordx4 a[68:71], v9, s[40:43], s52 offen offset:1024 sc1
    buffer_load_dwordx4 a[72:75], v7, s[40:43], s52 offen sc1
    buffer_load_dwordx4 a[76:79], v8, s[40:43], s52 offen sc1
    s_add_u32 s52, s52, 57472
    buffer_load_dwordx4 a[80:83], v9, s[40:43], s52 offen sc1
    buffer_load_dwordx4 a[84:87], v9, s[40:43], s52 offen offset:1024 sc1
    buffer_load_dwordx4 a[88:91], v7, s[40:43], s52 offen sc1
    buffer_load_dwordx4 a[92:95], v8, s[40:43], s52 offen sc1
    s_add_u32 s52, s52, 57472
    v_bfe_u32 v3, v1, 2, 2
    v_lshrrev_b32 v5, 5, v1
    v_lshl_add_u32 v5, v5, 3, v3
    v_mul_u32_u24 v220, 128, v5
    v_lshrrev_b32 v3, 1, v3
    v_lshl_add_u32 v220, v3, 6, v220
    v_bfe_u32 v3, v1, 4, 1
    v_lshl_add_u32 v220, v3, 5, v220
    v_and_b32 v3, 1, v1
    v_lshl_add_u32 v220, v3, 4, v220
    v_bfe_u32 v3, v1, 1, 1
    v_lshl_add_u32 v220, v3, 3, v220
    v_xor_b32 v221, 64, v220
    s_lshl_b32 s50, s55, 6
    v_xor_b32 v3, s50, v220
    v_xor_b32 v5, s50, v221
    v_add_u32 v216, s58, v3
    v_add_u32 v217, s58, v5
    s_add_u32 s48, s59, 57344
    v_add_u32 v218, s48, v3
    v_add_u32 v219, s48, v5
    v_add_u32 v222, 57344, v220
    v_add_u32 v223, 57344, v221
    s_waitcnt vmcnt(7) lgkmcnt(5)
    v_mfma_f32_32x32x16_bf16 v[44:59], a[64:67], v[20:23], 0
    s_waitcnt vmcnt(6) lgkmcnt(4)
    v_mfma_f32_32x32x16_bf16 v[44:59], a[68:71], v[24:27], v[44:59]
    s_waitcnt lgkmcnt(3)
    v_mfma_f32_32x32x16_bf16 v[60:75], a[64:67], v[28:31], 0
    s_nop 9
    v_exp_f32 v44, v44
    v_exp_f32 v45, v45
    v_exp_f32 v46, v46
    v_exp_f32 v47, v47
    s_waitcnt lgkmcnt(2)
    v_mfma_f32_32x32x16_bf16 v[60:75], a[68:71], v[32:35], v[60:75]
    v_exp_f32 v48, v48
    v_exp_f32 v49, v49
    v_exp_f32 v50, v50
    v_exp_f32 v51, v51
    v_exp_f32 v52, v52
    v_exp_f32 v53, v53
    v_exp_f32 v54, v54
    v_exp_f32 v55, v55
    buffer_load_dwordx4 a[96:99], v9, s[40:43], s52 offen sc1
    buffer_load_dwordx4 a[100:103], v9, s[40:43], s52 offen offset:1024 sc1
    buffer_load_dwordx4 a[104:107], v7, s[40:43], s52 offen sc1
    buffer_load_dwordx4 a[108:111], v8, s[40:43], s52 offen sc1
    s_add_u32 s52, s52, 57472
    v_exp_f32 v56, v56
    v_exp_f32 v57, v57
    v_exp_f32 v58, v58
    v_exp_f32 v59, v59
    s_waitcnt lgkmcnt(1)
    v_mfma_f32_32x32x16_bf16 v[76:91], a[64:67], v[36:39], 0
    v_exp_f32 v60, v60
    v_exp_f32 v61, v61
    v_exp_f32 v62, v62
    v_exp_f32 v63, v63
    s_waitcnt lgkmcnt(0)
    v_mfma_f32_32x32x16_bf16 v[76:91], a[68:71], v[40:43], v[76:91]
    v_exp_f32 v64, v64
    v_exp_f32 v65, v65
    v_exp_f32 v66, v66
    v_exp_f32 v67, v67
    s_waitcnt vmcnt(9)
    v_smfmac_f32_32x32x32_bf16 a[0:15], a[72:75], v[44:51], v11
    v_exp_f32 v68, v68
    v_exp_f32 v69, v69
    v_exp_f32 v70, v70
    v_exp_f32 v71, v71
    s_waitcnt vmcnt(8)
    v_smfmac_f32_32x32x32_bf16 a[0:15], a[76:79], v[52:59], v11
    s_waitcnt lgkmcnt(0)
    s_barrier
    v_exp_f32 v72, v72
    v_exp_f32 v73, v73
    v_exp_f32 v74, v74
    v_exp_f32 v75, v75
    v_mfma_f32_32x32x16_bf16 v[44:59], a[64:67], v[12:15], 0
    v_exp_f32 v76, v76
    v_exp_f32 v77, v77
    v_exp_f32 v78, v78
    v_exp_f32 v79, v79
    v_mfma_f32_32x32x16_bf16 v[44:59], a[68:71], v[16:19], v[44:59]
    v_exp_f32 v80, v80
    v_exp_f32 v81, v81
    v_exp_f32 v82, v82
    v_exp_f32 v83, v83
    v_smfmac_f32_32x32x32_bf16 a[16:31], a[72:75], v[60:67], v11
    v_exp_f32 v84, v84
    v_exp_f32 v85, v85
    v_exp_f32 v86, v86
    v_exp_f32 v87, v87
    v_smfmac_f32_32x32x32_bf16 a[16:31], a[76:79], v[68:75], v11
    buffer_load_dwordx4 a[112:115], v9, s[40:43], s52 offen sc1
    buffer_load_dwordx4 a[116:119], v9, s[40:43], s52 offen offset:1024 sc1
    buffer_load_dwordx4 a[120:123], v7, s[40:43], s52 offen sc1
    buffer_load_dwordx4 a[124:127], v8, s[40:43], s52 offen sc1
    s_add_u32 s52, s52, 57472
    v_exp_f32 v88, v88
    v_exp_f32 v89, v89
    v_exp_f32 v90, v90
    v_exp_f32 v91, v91
    s_waitcnt vmcnt(8)
    v_mfma_f32_32x32x16_bf16 v[60:75], a[80:83], v[20:23], 0
    v_exp_f32 v44, v44
    v_exp_f32 v45, v45
    v_exp_f32 v46, v46
    v_exp_f32 v47, v47
    v_mfma_f32_32x32x16_bf16 v[60:75], a[84:87], v[24:27], v[60:75]
    v_exp_f32 v48, v48
    v_exp_f32 v49, v49
    v_exp_f32 v50, v50
    v_exp_f32 v51, v51
    v_smfmac_f32_32x32x32_bf16 a[32:47], a[72:75], v[76:83], v11
    v_exp_f32 v52, v52
    v_exp_f32 v53, v53
    v_exp_f32 v54, v54
    v_exp_f32 v55, v55
    v_smfmac_f32_32x32x32_bf16 a[32:47], a[76:79], v[84:91], v11
    s_add_u32 m0, s58, 0
    s_add_u32 s51, s100, 172032
    buffer_load_dwordx4 v184, s[28:31], s51 offen lds
    buffer_load_dwordx4 v185, s[28:31], s51 offen offset:1024 lds
    v_exp_f32 v56, v56
    v_exp_f32 v57, v57
    v_exp_f32 v58, v58
    v_exp_f32 v59, v59
    v_mfma_f32_32x32x16_bf16 v[76:91], a[80:83], v[28:31], 0
    v_exp_f32 v60, v60
    v_exp_f32 v61, v61
    v_exp_f32 v62, v62
    v_exp_f32 v63, v63
    v_mfma_f32_32x32x16_bf16 v[76:91], a[84:87], v[32:35], v[76:91]
    v_exp_f32 v64, v64
    v_exp_f32 v65, v65
    v_exp_f32 v66, v66
    v_exp_f32 v67, v67
    v_smfmac_f32_32x32x32_bf16 v[196:211], a[72:75], v[44:51], v11
    v_exp_f32 v68, v68
    v_exp_f32 v69, v69
    v_exp_f32 v70, v70
    v_exp_f32 v71, v71
    v_smfmac_f32_32x32x32_bf16 v[196:211], a[76:79], v[52:59], v11
    buffer_load_dwordx4 a[64:67], v9, s[40:43], s52 offen sc1
    buffer_load_dwordx4 a[68:71], v9, s[40:43], s52 offen offset:1024 sc1
    buffer_load_dwordx4 a[72:75], v7, s[40:43], s52 offen sc1
    buffer_load_dwordx4 a[76:79], v8, s[40:43], s52 offen sc1
    s_add_u32 s52, s52, 57472
    v_exp_f32 v72, v72
    v_exp_f32 v73, v73
    v_exp_f32 v74, v74
    v_exp_f32 v75, v75
    v_mfma_f32_32x32x16_bf16 v[44:59], a[80:83], v[36:39], 0
    v_exp_f32 v76, v76
    v_exp_f32 v77, v77
    v_exp_f32 v78, v78
    v_exp_f32 v79, v79
    v_mfma_f32_32x32x16_bf16 v[44:59], a[84:87], v[40:43], v[44:59]
    v_exp_f32 v80, v80
    v_exp_f32 v81, v81
    v_exp_f32 v82, v82
    v_exp_f32 v83, v83
    v_smfmac_f32_32x32x32_bf16 a[0:15], a[88:91], v[60:67], v11
    v_exp_f32 v84, v84
    v_exp_f32 v85, v85
    v_exp_f32 v86, v86
    v_exp_f32 v87, v87
    v_smfmac_f32_32x32x32_bf16 a[0:15], a[92:95], v[68:75], v11
    buffer_load_dwordx4 v186, s[28:31], s51 offen offset:2048 lds
    buffer_load_dwordx4 v187, s[28:31], s51 offen offset:3072 lds
    v_exp_f32 v88, v88
    v_exp_f32 v89, v89
    v_exp_f32 v90, v90
    v_exp_f32 v91, v91
    v_mfma_f32_32x32x16_bf16 v[60:75], a[80:83], v[12:15], 0
    v_exp_f32 v44, v44
    v_exp_f32 v45, v45
    v_exp_f32 v46, v46
    v_exp_f32 v47, v47
    v_mfma_f32_32x32x16_bf16 v[60:75], a[84:87], v[16:19], v[60:75]
    v_exp_f32 v48, v48
    v_exp_f32 v49, v49
    v_exp_f32 v50, v50
    v_exp_f32 v51, v51
    v_smfmac_f32_32x32x32_bf16 a[16:31], a[88:91], v[76:83], v11
    v_exp_f32 v52, v52
    v_exp_f32 v53, v53
    v_exp_f32 v54, v54
    v_exp_f32 v55, v55
    v_smfmac_f32_32x32x32_bf16 a[16:31], a[92:95], v[84:91], v11
    s_add_u32 m0, s59, 0
    s_add_u32 s51, s53, 0
    buffer_load_dwordx4 v184, s[16:19], s51 offen offset:0 lds
    buffer_load_dwordx4 v185, s[16:19], s51 offen offset:1024 lds
    v_exp_f32 v56, v56
    v_exp_f32 v57, v57
    v_exp_f32 v58, v58
    v_exp_f32 v59, v59
    s_waitcnt vmcnt(14)
    v_mfma_f32_32x32x16_bf16 v[76:91], a[96:99], v[20:23], 0
    v_exp_f32 v60, v60
    v_exp_f32 v61, v61
    v_exp_f32 v62, v62
    v_exp_f32 v63, v63
    v_mfma_f32_32x32x16_bf16 v[76:91], a[100:103], v[24:27], v[76:91]
    v_exp_f32 v64, v64
    v_exp_f32 v65, v65
    v_exp_f32 v66, v66
    v_exp_f32 v67, v67
    v_smfmac_f32_32x32x32_bf16 a[32:47], a[88:91], v[44:51], v11
    v_exp_f32 v68, v68
    v_exp_f32 v69, v69
    v_exp_f32 v70, v70
    v_exp_f32 v71, v71
    v_smfmac_f32_32x32x32_bf16 a[32:47], a[92:95], v[52:59], v11
    buffer_load_dwordx4 v186, s[16:19], s51 offen offset:2048 lds
    buffer_load_dwordx4 v187, s[16:19], s51 offen offset:3072 lds
    v_exp_f32 v72, v72
    v_exp_f32 v73, v73
    v_exp_f32 v74, v74
    v_exp_f32 v75, v75
    v_mfma_f32_32x32x16_bf16 v[44:59], a[96:99], v[28:31], 0
    v_exp_f32 v76, v76
    v_exp_f32 v77, v77
    v_exp_f32 v78, v78
    v_exp_f32 v79, v79
    v_mfma_f32_32x32x16_bf16 v[44:59], a[100:103], v[32:35], v[44:59]
    v_exp_f32 v80, v80
    v_exp_f32 v81, v81
    v_exp_f32 v82, v82
    v_exp_f32 v83, v83
    v_smfmac_f32_32x32x32_bf16 v[196:211], a[88:91], v[60:67], v11
    v_exp_f32 v84, v84
    v_exp_f32 v85, v85
    v_exp_f32 v86, v86
    v_exp_f32 v87, v87
    v_smfmac_f32_32x32x32_bf16 v[196:211], a[92:95], v[68:75], v11
    buffer_load_dwordx4 a[80:83], v9, s[40:43], s52 offen sc1
    buffer_load_dwordx4 a[84:87], v9, s[40:43], s52 offen offset:1024 sc1
    buffer_load_dwordx4 a[88:91], v7, s[40:43], s52 offen sc1
    buffer_load_dwordx4 a[92:95], v8, s[40:43], s52 offen sc1
    s_add_u32 s52, s52, 57472
    v_exp_f32 v88, v88
    v_exp_f32 v89, v89
    v_exp_f32 v90, v90
    v_exp_f32 v91, v91
    v_mfma_f32_32x32x16_bf16 v[60:75], a[96:99], v[36:39], 0
    v_exp_f32 v44, v44
    v_exp_f32 v45, v45
    v_exp_f32 v46, v46
    v_exp_f32 v47, v47
    v_mfma_f32_32x32x16_bf16 v[60:75], a[100:103], v[40:43], v[60:75]
    v_exp_f32 v48, v48
    v_exp_f32 v49, v49
    v_exp_f32 v50, v50
    v_exp_f32 v51, v51
    v_smfmac_f32_32x32x32_bf16 a[0:15], a[104:107], v[76:83], v11
    v_exp_f32 v52, v52
    v_exp_f32 v53, v53
    v_exp_f32 v54, v54
    v_exp_f32 v55, v55
    v_smfmac_f32_32x32x32_bf16 a[0:15], a[108:111], v[84:91], v11
    s_add_u32 m0, s58, 4096
    s_add_u32 s51, s100, 802816
    buffer_load_dwordx4 v184, s[28:31], s51 offen lds
    buffer_load_dwordx4 v185, s[28:31], s51 offen offset:1024 lds
    v_exp_f32 v56, v56
    v_exp_f32 v57, v57
    v_exp_f32 v58, v58
    v_exp_f32 v59, v59
    v_mfma_f32_32x32x16_bf16 v[76:91], a[96:99], v[12:15], 0
    v_exp_f32 v60, v60
    v_exp_f32 v61, v61
    v_exp_f32 v62, v62
    v_exp_f32 v63, v63
    v_mfma_f32_32x32x16_bf16 v[76:91], a[100:103], v[16:19], v[76:91]
    v_exp_f32 v64, v64
    v_exp_f32 v65, v65
    v_exp_f32 v66, v66
    v_exp_f32 v67, v67
    v_smfmac_f32_32x32x32_bf16 a[16:31], a[104:107], v[44:51], v11
    v_exp_f32 v68, v68
    v_exp_f32 v69, v69
    v_exp_f32 v70, v70
    v_exp_f32 v71, v71
    v_smfmac_f32_32x32x32_bf16 a[16:31], a[108:111], v[52:59], v11
    buffer_load_dwordx4 v186, s[28:31], s51 offen offset:2048 lds
    buffer_load_dwordx4 v187, s[28:31], s51 offen offset:3072 lds
    v_exp_f32 v72, v72
    v_exp_f32 v73, v73
    v_exp_f32 v74, v74
    v_exp_f32 v75, v75
    s_waitcnt vmcnt(20)
    v_mfma_f32_32x32x16_bf16 v[44:59], a[112:115], v[20:23], 0
    v_exp_f32 v76, v76
    v_exp_f32 v77, v77
    v_exp_f32 v78, v78
    v_exp_f32 v79, v79
    v_mfma_f32_32x32x16_bf16 v[44:59], a[116:119], v[24:27], v[44:59]
    v_exp_f32 v80, v80
    v_exp_f32 v81, v81
    v_exp_f32 v82, v82
    v_exp_f32 v83, v83
    v_smfmac_f32_32x32x32_bf16 a[32:47], a[104:107], v[60:67], v11
    v_exp_f32 v84, v84
    v_exp_f32 v85, v85
    v_exp_f32 v86, v86
    v_exp_f32 v87, v87
    v_smfmac_f32_32x32x32_bf16 a[32:47], a[108:111], v[68:75], v11
    s_add_u32 m0, s59, 4096
    s_add_u32 s51, s53, 28672
    buffer_load_dwordx4 v184, s[16:19], s51 offen offset:0 lds
    buffer_load_dwordx4 v185, s[16:19], s51 offen offset:1024 lds
    v_exp_f32 v88, v88
    v_exp_f32 v89, v89
    v_exp_f32 v90, v90
    v_exp_f32 v91, v91
    v_mfma_f32_32x32x16_bf16 v[60:75], a[112:115], v[28:31], 0
    v_exp_f32 v44, v44
    v_exp_f32 v45, v45
    v_exp_f32 v46, v46
    v_exp_f32 v47, v47
    v_mfma_f32_32x32x16_bf16 v[60:75], a[116:119], v[32:35], v[60:75]
    v_exp_f32 v48, v48
    v_exp_f32 v49, v49
    v_exp_f32 v50, v50
    v_exp_f32 v51, v51
    v_smfmac_f32_32x32x32_bf16 v[196:211], a[104:107], v[76:83], v11
    v_exp_f32 v52, v52
    v_exp_f32 v53, v53
    v_exp_f32 v54, v54
    v_exp_f32 v55, v55
    v_smfmac_f32_32x32x32_bf16 v[196:211], a[108:111], v[84:91], v11
    buffer_load_dwordx4 a[96:99], v9, s[40:43], s52 offen sc1
    buffer_load_dwordx4 a[100:103], v9, s[40:43], s52 offen offset:1024 sc1
    buffer_load_dwordx4 a[104:107], v7, s[40:43], s52 offen sc1
    buffer_load_dwordx4 a[108:111], v8, s[40:43], s52 offen sc1
    s_add_u32 s52, s52, 57472
    v_exp_f32 v56, v56
    v_exp_f32 v57, v57
    v_exp_f32 v58, v58
    v_exp_f32 v59, v59
    v_mfma_f32_32x32x16_bf16 v[76:91], a[112:115], v[36:39], 0
    v_exp_f32 v60, v60
    v_exp_f32 v61, v61
    v_exp_f32 v62, v62
    v_exp_f32 v63, v63
    v_mfma_f32_32x32x16_bf16 v[76:91], a[116:119], v[40:43], v[76:91]
    v_exp_f32 v64, v64
    v_exp_f32 v65, v65
    v_exp_f32 v66, v66
    v_exp_f32 v67, v67
    v_smfmac_f32_32x32x32_bf16 a[0:15], a[120:123], v[44:51], v11
    v_exp_f32 v68, v68
    v_exp_f32 v69, v69
    v_exp_f32 v70, v70
    v_exp_f32 v71, v71
    v_smfmac_f32_32x32x32_bf16 a[0:15], a[124:127], v[52:59], v11
    buffer_load_dwordx4 v186, s[16:19], s51 offen offset:2048 lds
    buffer_load_dwordx4 v187, s[16:19], s51 offen offset:3072 lds
    v_exp_f32 v72, v72
    v_exp_f32 v73, v73
    v_exp_f32 v74, v74
    v_exp_f32 v75, v75
    v_mfma_f32_32x32x16_bf16 v[44:59], a[112:115], v[12:15], 0
    v_exp_f32 v76, v76
    v_exp_f32 v77, v77
    v_exp_f32 v78, v78
    v_exp_f32 v79, v79
    v_mfma_f32_32x32x16_bf16 v[44:59], a[116:119], v[16:19], v[44:59]
    s_waitcnt vmcnt(20)
    ds_read_b64_tr_b16 a[128:129], v216 offset:0
    v_exp_f32 v80, v80
    v_exp_f32 v81, v81
    v_exp_f32 v82, v82
    v_exp_f32 v83, v83
    v_smfmac_f32_32x32x32_bf16 a[16:31], a[120:123], v[60:67], v11
    ds_read_b64_tr_b16 a[130:131], v216 offset:512
    v_exp_f32 v84, v84
    v_exp_f32 v85, v85
    v_exp_f32 v86, v86
    v_exp_f32 v87, v87
    v_smfmac_f32_32x32x32_bf16 a[16:31], a[124:127], v[68:75], v11
    s_add_u32 m0, s58, 8192
    s_add_u32 s51, s100, 831488
    buffer_load_dwordx4 v184, s[28:31], s51 offen lds
    buffer_load_dwordx4 v185, s[28:31], s51 offen offset:1024 lds
    ds_read_b64_tr_b16 a[132:133], v217 offset:0
    v_exp_f32 v88, v88
    v_exp_f32 v89, v89
    v_exp_f32 v90, v90
    v_exp_f32 v91, v91
    v_mfma_f32_32x32x16_bf16 v[60:75], a[64:67], v[20:23], 0
    v_exp_f32 v44, v44
    v_exp_f32 v45, v45
    v_exp_f32 v46, v46
    v_exp_f32 v47, v47
    v_mfma_f32_32x32x16_bf16 v[60:75], a[68:71], v[24:27], v[60:75]
    ds_read_b64_tr_b16 a[134:135], v217 offset:512
    v_exp_f32 v48, v48
    v_exp_f32 v49, v49
    v_exp_f32 v50, v50
    v_exp_f32 v51, v51
    v_smfmac_f32_32x32x32_bf16 a[32:47], a[120:123], v[76:83], v11
    ds_read_b64_tr_b16 a[136:137], v216 offset:2048
    v_exp_f32 v52, v52
    v_exp_f32 v53, v53
    v_exp_f32 v54, v54
    v_exp_f32 v55, v55
    v_smfmac_f32_32x32x32_bf16 a[32:47], a[124:127], v[84:91], v11
    buffer_load_dwordx4 v186, s[28:31], s51 offen offset:2048 lds
    buffer_load_dwordx4 v187, s[28:31], s51 offen offset:3072 lds
    ds_read_b64_tr_b16 a[138:139], v216 offset:2560
    v_exp_f32 v56, v56
    v_exp_f32 v57, v57
    v_exp_f32 v58, v58
    v_exp_f32 v59, v59
    v_mfma_f32_32x32x16_bf16 v[76:91], a[64:67], v[28:31], 0
    v_exp_f32 v60, v60
    v_exp_f32 v61, v61
    v_exp_f32 v62, v62
    v_exp_f32 v63, v63
    v_mfma_f32_32x32x16_bf16 v[76:91], a[68:71], v[32:35], v[76:91]
    ds_read_b64_tr_b16 a[140:141], v217 offset:2048
    v_exp_f32 v64, v64
    v_exp_f32 v65, v65
    v_exp_f32 v66, v66
    v_exp_f32 v67, v67
    v_smfmac_f32_32x32x32_bf16 v[196:211], a[120:123], v[44:51], v11
    ds_read_b64_tr_b16 a[142:143], v217 offset:2560
    v_exp_f32 v68, v68
    v_exp_f32 v69, v69
    v_exp_f32 v70, v70
    v_exp_f32 v71, v71
    v_smfmac_f32_32x32x32_bf16 v[196:211], a[124:127], v[52:59], v11
    buffer_load_dwordx4 a[112:115], v9, s[40:43], s52 offen sc1
    buffer_load_dwordx4 a[116:119], v9, s[40:43], s52 offen offset:1024 sc1
    buffer_load_dwordx4 a[120:123], v7, s[40:43], s52 offen sc1
    buffer_load_dwordx4 a[124:127], v8, s[40:43], s52 offen sc1
    s_add_u32 s52, s52, 57472
    v_exp_f32 v72, v72
    v_exp_f32 v73, v73
    v_exp_f32 v74, v74
    v_exp_f32 v75, v75
    v_mfma_f32_32x32x16_bf16 v[44:59], a[64:67], v[36:39], 0
    v_exp_f32 v76, v76
    v_exp_f32 v77, v77
    v_exp_f32 v78, v78
    v_exp_f32 v79, v79
    v_mfma_f32_32x32x16_bf16 v[44:59], a[68:71], v[40:43], v[44:59]
    v_exp_f32 v80, v80
    v_exp_f32 v81, v81
    v_exp_f32 v82, v82
    v_exp_f32 v83, v83
    v_smfmac_f32_32x32x32_bf16 a[0:15], a[72:75], v[60:67], v11
    v_exp_f32 v84, v84
    v_exp_f32 v85, v85
    v_exp_f32 v86, v86
    v_exp_f32 v87, v87
    v_smfmac_f32_32x32x32_bf16 a[0:15], a[76:79], v[68:75], v11
    s_add_u32 m0, s59, 8192
    s_add_u32 s51, s53, 57344
    buffer_load_dwordx4 v184, s[16:19], s51 offen offset:0 lds
    buffer_load_dwordx4 v185, s[16:19], s51 offen offset:1024 lds
    v_exp_f32 v88, v88
    v_exp_f32 v89, v89
    v_exp_f32 v90, v90
    v_exp_f32 v91, v91
    v_mfma_f32_32x32x16_bf16 v[60:75], a[64:67], v[12:15], 0
    v_exp_f32 v44, v44
    v_exp_f32 v45, v45
    v_exp_f32 v46, v46
    v_exp_f32 v47, v47
    v_mfma_f32_32x32x16_bf16 v[60:75], a[68:71], v[16:19], v[60:75]
    v_exp_f32 v48, v48
    v_exp_f32 v49, v49
    v_exp_f32 v50, v50
    v_exp_f32 v51, v51
    v_smfmac_f32_32x32x32_bf16 a[16:31], a[72:75], v[76:83], v11
    v_exp_f32 v52, v52
    v_exp_f32 v53, v53
    v_exp_f32 v54, v54
    v_exp_f32 v55, v55
    v_smfmac_f32_32x32x32_bf16 a[16:31], a[76:79], v[84:91], v11
    buffer_load_dwordx4 v186, s[16:19], s51 offen offset:2048 lds
    buffer_load_dwordx4 v187, s[16:19], s51 offen offset:3072 lds
    v_exp_f32 v56, v56
    v_exp_f32 v57, v57
    v_exp_f32 v58, v58
    v_exp_f32 v59, v59
    s_waitcnt vmcnt(24)
    v_mfma_f32_32x32x16_bf16 v[76:91], a[80:83], v[20:23], 0
    v_exp_f32 v60, v60
    v_exp_f32 v61, v61
    v_exp_f32 v62, v62
    v_exp_f32 v63, v63
    v_mfma_f32_32x32x16_bf16 v[76:91], a[84:87], v[24:27], v[76:91]
    s_waitcnt vmcnt(20)
    ds_read_b64_tr_b16 a[144:145], v216 offset:4096
    v_exp_f32 v64, v64
    v_exp_f32 v65, v65
    v_exp_f32 v66, v66
    v_exp_f32 v67, v67
    v_smfmac_f32_32x32x32_bf16 a[32:47], a[72:75], v[44:51], v11
    ds_read_b64_tr_b16 a[146:147], v216 offset:4608
    v_exp_f32 v68, v68
    v_exp_f32 v69, v69
    v_exp_f32 v70, v70
    v_exp_f32 v71, v71
    v_smfmac_f32_32x32x32_bf16 a[32:47], a[76:79], v[52:59], v11
    s_waitcnt lgkmcnt(2)
    s_add_u32 m0, s58, 0
    s_add_u32 s51, s100, 860160
    buffer_load_dwordx4 v184, s[28:31], s51 offen lds
    buffer_load_dwordx4 v185, s[28:31], s51 offen offset:1024 lds
    ds_read_b64_tr_b16 a[148:149], v217 offset:4096
    v_exp_f32 v72, v72
    v_exp_f32 v73, v73
    v_exp_f32 v74, v74
    v_exp_f32 v75, v75
    v_mfma_f32_32x32x16_bf16 v[44:59], a[80:83], v[28:31], 0
    v_exp_f32 v76, v76
    v_exp_f32 v77, v77
    v_exp_f32 v78, v78
    v_exp_f32 v79, v79
    v_mfma_f32_32x32x16_bf16 v[44:59], a[84:87], v[32:35], v[44:59]
    ds_read_b64_tr_b16 a[150:151], v217 offset:4608
    v_exp_f32 v80, v80
    v_exp_f32 v81, v81
    v_exp_f32 v82, v82
    v_exp_f32 v83, v83
    v_smfmac_f32_32x32x32_bf16 v[196:211], a[72:75], v[60:67], v11
    ds_read_b64_tr_b16 a[152:153], v216 offset:6144
    v_exp_f32 v84, v84
    v_exp_f32 v85, v85
    v_exp_f32 v86, v86
    v_exp_f32 v87, v87
    v_smfmac_f32_32x32x32_bf16 v[196:211], a[76:79], v[68:75], v11
    buffer_load_dwordx4 a[64:67], v9, s[40:43], s52 offen sc1
    buffer_load_dwordx4 a[68:71], v9, s[40:43], s52 offen offset:1024 sc1
    buffer_load_dwordx4 a[72:75], v7, s[40:43], s52 offen sc1
    buffer_load_dwordx4 a[76:79], v8, s[40:43], s52 offen sc1
    s_add_u32 s52, s52, 57472
    ds_read_b64_tr_b16 a[154:155], v216 offset:6656
    v_exp_f32 v88, v88
    v_exp_f32 v89, v89
    v_exp_f32 v90, v90
    v_exp_f32 v91, v91
    v_mfma_f32_32x32x16_bf16 v[60:75], a[80:83], v[36:39], 0
    v_exp_f32 v44, v44
    v_exp_f32 v45, v45
    v_exp_f32 v46, v46
    v_exp_f32 v47, v47
    v_mfma_f32_32x32x16_bf16 v[60:75], a[84:87], v[40:43], v[60:75]
    ds_read_b64_tr_b16 a[156:157], v217 offset:6144
    v_exp_f32 v48, v48
    v_exp_f32 v49, v49
    v_exp_f32 v50, v50
    v_exp_f32 v51, v51
    v_smfmac_f32_32x32x32_bf16 a[0:15], a[88:91], v[76:83], v11
    ds_read_b64_tr_b16 a[158:159], v217 offset:6656
    v_exp_f32 v52, v52
    v_exp_f32 v53, v53
    v_exp_f32 v54, v54
    v_exp_f32 v55, v55
    v_smfmac_f32_32x32x32_bf16 a[0:15], a[92:95], v[84:91], v11
    buffer_load_dwordx4 v186, s[28:31], s51 offen offset:2048 lds
    buffer_load_dwordx4 v187, s[28:31], s51 offen offset:3072 lds
    v_exp_f32 v56, v56
    v_exp_f32 v57, v57
    v_exp_f32 v58, v58
    v_exp_f32 v59, v59
    v_mfma_f32_32x32x16_bf16 v[76:91], a[80:83], v[12:15], 0
    v_exp_f32 v60, v60
    v_exp_f32 v61, v61
    v_exp_f32 v62, v62
    v_exp_f32 v63, v63
    v_mfma_f32_32x32x16_bf16 v[76:91], a[84:87], v[16:19], v[76:91]
    v_exp_f32 v64, v64
    v_exp_f32 v65, v65
    v_exp_f32 v66, v66
    v_exp_f32 v67, v67
    v_smfmac_f32_32x32x32_bf16 a[16:31], a[88:91], v[44:51], v11
    v_exp_f32 v68, v68
    v_exp_f32 v69, v69
    v_exp_f32 v70, v70
    v_exp_f32 v71, v71
    v_smfmac_f32_32x32x32_bf16 a[16:31], a[92:95], v[52:59], v11
    s_add_u32 m0, s59, 12288
    s_add_u32 s51, s53, 86016
    buffer_load_dwordx4 v184, s[16:19], s51 offen offset:0 lds
    buffer_load_dwordx4 v185, s[16:19], s51 offen offset:1024 lds
    v_exp_f32 v72, v72
    v_exp_f32 v73, v73
    v_exp_f32 v74, v74
    v_exp_f32 v75, v75
    s_waitcnt vmcnt(24)
    v_mfma_f32_32x32x16_bf16 v[44:59], a[96:99], v[20:23], 0
    v_exp_f32 v76, v76
    v_exp_f32 v77, v77
    v_exp_f32 v78, v78
    v_exp_f32 v79, v79
    v_mfma_f32_32x32x16_bf16 v[44:59], a[100:103], v[24:27], v[44:59]
    v_exp_f32 v80, v80
    v_exp_f32 v81, v81
    v_exp_f32 v82, v82
    v_exp_f32 v83, v83
    v_smfmac_f32_32x32x32_bf16 a[32:47], a[88:91], v[60:67], v11
    v_exp_f32 v84, v84
    v_exp_f32 v85, v85
    v_exp_f32 v86, v86
    v_exp_f32 v87, v87
    v_smfmac_f32_32x32x32_bf16 a[32:47], a[92:95], v[68:75], v11
    s_waitcnt lgkmcnt(0)
    s_add_u32 m0, s58, 4096
    s_add_u32 s51, s100, 888832
    buffer_load_dwordx4 v184, s[28:31], s51 offen lds
    buffer_load_dwordx4 v185, s[28:31], s51 offen offset:1024 lds
    v_exp_f32 v88, v88
    v_exp_f32 v89, v89
    v_exp_f32 v90, v90
    v_exp_f32 v91, v91
    v_mfma_f32_32x32x16_bf16 v[60:75], a[96:99], v[28:31], 0
    v_exp_f32 v44, v44
    v_exp_f32 v45, v45
    v_exp_f32 v46, v46
    v_exp_f32 v47, v47
    v_mfma_f32_32x32x16_bf16 v[60:75], a[100:103], v[32:35], v[60:75]
    s_waitcnt vmcnt(20)
    ds_read_b64_tr_b16 a[160:161], v216 offset:8192
    v_exp_f32 v48, v48
    v_exp_f32 v49, v49
    v_exp_f32 v50, v50
    v_exp_f32 v51, v51
    v_smfmac_f32_32x32x32_bf16 v[196:211], a[88:91], v[76:83], v11
    ds_read_b64_tr_b16 a[162:163], v216 offset:8704
    v_exp_f32 v52, v52
    v_exp_f32 v53, v53
    v_exp_f32 v54, v54
    v_exp_f32 v55, v55
    v_smfmac_f32_32x32x32_bf16 v[196:211], a[92:95], v[84:91], v11
    buffer_load_dwordx4 a[80:83], v9, s[40:43], s52 offen sc1
    buffer_load_dwordx4 a[84:87], v9, s[40:43], s52 offen offset:1024 sc1
    buffer_load_dwordx4 a[88:91], v7, s[40:43], s52 offen sc1
    buffer_load_dwordx4 a[92:95], v8, s[40:43], s52 offen sc1
    s_add_u32 s52, s52, 57472
    ds_read_b64_tr_b16 a[164:165], v217 offset:8192
    v_exp_f32 v56, v56
    v_exp_f32 v57, v57
    v_exp_f32 v58, v58
    v_exp_f32 v59, v59
    v_mfma_f32_32x32x16_bf16 v[76:91], a[96:99], v[36:39], 0
    v_exp_f32 v60, v60
    v_exp_f32 v61, v61
    v_exp_f32 v62, v62
    v_exp_f32 v63, v63
    v_mfma_f32_32x32x16_bf16 v[76:91], a[100:103], v[40:43], v[76:91]
    ds_read_b64_tr_b16 a[166:167], v217 offset:8704
    v_exp_f32 v64, v64
    v_exp_f32 v65, v65
    v_exp_f32 v66, v66
    v_exp_f32 v67, v67
    v_smfmac_f32_32x32x32_bf16 a[0:15], a[104:107], v[44:51], v11
    ds_read_b64_tr_b16 a[168:169], v216 offset:10240
    v_exp_f32 v68, v68
    v_exp_f32 v69, v69
    v_exp_f32 v70, v70
    v_exp_f32 v71, v71
    v_smfmac_f32_32x32x32_bf16 a[0:15], a[108:111], v[52:59], v11
    buffer_load_dwordx4 v186, s[28:31], s51 offen offset:2048 lds
    buffer_load_dwordx4 v187, s[28:31], s51 offen offset:3072 lds
    ds_read_b64_tr_b16 a[170:171], v216 offset:10752
    v_exp_f32 v72, v72
    v_exp_f32 v73, v73
    v_exp_f32 v74, v74
    v_exp_f32 v75, v75
    v_mfma_f32_32x32x16_bf16 v[44:59], a[96:99], v[12:15], 0
    v_exp_f32 v76, v76
    v_exp_f32 v77, v77
    v_exp_f32 v78, v78
    v_exp_f32 v79, v79
    v_mfma_f32_32x32x16_bf16 v[44:59], a[100:103], v[16:19], v[44:59]
    ds_read_b64_tr_b16 a[172:173], v217 offset:10240
    v_exp_f32 v80, v80
    v_exp_f32 v81, v81
    v_exp_f32 v82, v82
    v_exp_f32 v83, v83
    v_smfmac_f32_32x32x32_bf16 a[16:31], a[104:107], v[60:67], v11
    ds_read_b64_tr_b16 a[174:175], v217 offset:10752
    v_exp_f32 v84, v84
    v_exp_f32 v85, v85
    v_exp_f32 v86, v86
    v_exp_f32 v87, v87
    v_smfmac_f32_32x32x32_bf16 a[16:31], a[108:111], v[68:75], v11
    s_add_u32 m0, s59, 57344
    s_add_u32 s51, s99, 0
    buffer_load_dwordx4 v188, s[20:23], s51 offen offset:0 lds
    buffer_load_dwordx4 v189, s[20:23], s51 offen offset:1024 lds
    v_exp_f32 v88, v88
    v_exp_f32 v89, v89
    v_exp_f32 v90, v90
    v_exp_f32 v91, v91
    s_waitcnt vmcnt(24)
    v_mfma_f32_32x32x16_bf16 v[60:75], a[112:115], v[20:23], 0
    v_exp_f32 v44, v44
    v_exp_f32 v45, v45
    v_exp_f32 v46, v46
    v_exp_f32 v47, v47
    v_mfma_f32_32x32x16_bf16 v[60:75], a[116:119], v[24:27], v[60:75]
    v_exp_f32 v48, v48
    v_exp_f32 v49, v49
    v_exp_f32 v50, v50
    v_exp_f32 v51, v51
    v_smfmac_f32_32x32x32_bf16 a[32:47], a[104:107], v[76:83], v11
    v_exp_f32 v52, v52
    v_exp_f32 v53, v53
    v_exp_f32 v54, v54
    v_exp_f32 v55, v55
    v_smfmac_f32_32x32x32_bf16 a[32:47], a[108:111], v[84:91], v11
    buffer_load_dwordx4 v190, s[20:23], s51 offen offset:2048 lds
    buffer_load_dwordx4 v191, s[20:23], s51 offen offset:3072 lds
    v_exp_f32 v56, v56
    v_exp_f32 v57, v57
    v_exp_f32 v58, v58
    v_exp_f32 v59, v59
    v_mfma_f32_32x32x16_bf16 v[76:91], a[112:115], v[28:31], 0
    v_exp_f32 v60, v60
    v_exp_f32 v61, v61
    v_exp_f32 v62, v62
    v_exp_f32 v63, v63
    v_mfma_f32_32x32x16_bf16 v[76:91], a[116:119], v[32:35], v[76:91]
    v_exp_f32 v64, v64
    v_exp_f32 v65, v65
    v_exp_f32 v66, v66
    v_exp_f32 v67, v67
    v_smfmac_f32_32x32x32_bf16 v[196:211], a[104:107], v[44:51], v11
    v_exp_f32 v68, v68
    v_exp_f32 v69, v69
    v_exp_f32 v70, v70
    v_exp_f32 v71, v71
    v_smfmac_f32_32x32x32_bf16 v[196:211], a[108:111], v[52:59], v11
    buffer_load_dwordx4 a[96:99], v9, s[40:43], s52 offen sc1
    buffer_load_dwordx4 a[100:103], v9, s[40:43], s52 offen offset:1024 sc1
    buffer_load_dwordx4 a[104:107], v7, s[40:43], s52 offen sc1
    buffer_load_dwordx4 a[108:111], v8, s[40:43], s52 offen sc1
    s_add_u32 s52, s52, 57472
    v_exp_f32 v72, v72
    v_exp_f32 v73, v73
    v_exp_f32 v74, v74
    v_exp_f32 v75, v75
    v_mfma_f32_32x32x16_bf16 v[44:59], a[112:115], v[36:39], 0
    v_exp_f32 v76, v76
    v_exp_f32 v77, v77
    v_exp_f32 v78, v78
    v_exp_f32 v79, v79
    v_mfma_f32_32x32x16_bf16 v[44:59], a[116:119], v[40:43], v[44:59]
    v_exp_f32 v80, v80
    v_exp_f32 v81, v81
    v_exp_f32 v82, v82
    v_exp_f32 v83, v83
    v_smfmac_f32_32x32x32_bf16 a[0:15], a[120:123], v[60:67], v11
    v_exp_f32 v84, v84
    v_exp_f32 v85, v85
    v_exp_f32 v86, v86
    v_exp_f32 v87, v87
    v_smfmac_f32_32x32x32_bf16 a[0:15], a[124:127], v[68:75], v11
    s_waitcnt lgkmcnt(0)
    s_add_u32 m0, s58, 8192
    s_add_u32 s51, s100, 917504
    buffer_load_dwordx4 v184, s[28:31], s51 offen lds
    buffer_load_dwordx4 v185, s[28:31], s51 offen offset:1024 lds
    v_exp_f32 v88, v88
    v_exp_f32 v89, v89
    v_exp_f32 v90, v90
    v_exp_f32 v91, v91
    v_mfma_f32_32x32x16_bf16 v[60:75], a[112:115], v[12:15], 0
    v_exp_f32 v44, v44
    v_exp_f32 v45, v45
    v_exp_f32 v46, v46
    v_exp_f32 v47, v47
    v_mfma_f32_32x32x16_bf16 v[60:75], a[116:119], v[16:19], v[60:75]
    s_waitcnt vmcnt(20)
    ds_read_b64_tr_b16 a[176:177], v216 offset:0
    v_exp_f32 v48, v48
    v_exp_f32 v49, v49
    v_exp_f32 v50, v50
    v_exp_f32 v51, v51
    v_smfmac_f32_32x32x32_bf16 a[16:31], a[120:123], v[76:83], v11
    ds_read_b64_tr_b16 a[178:179], v216 offset:512
    v_exp_f32 v52, v52
    v_exp_f32 v53, v53
    v_exp_f32 v54, v54
    v_exp_f32 v55, v55
    v_smfmac_f32_32x32x32_bf16 a[16:31], a[124:127], v[84:91], v11
    buffer_load_dwordx4 v186, s[28:31], s51 offen offset:2048 lds
    buffer_load_dwordx4 v187, s[28:31], s51 offen offset:3072 lds
    ds_read_b64_tr_b16 a[180:181], v217 offset:0
    v_exp_f32 v56, v56
    v_exp_f32 v57, v57
    v_exp_f32 v58, v58
    v_exp_f32 v59, v59
    v_mfma_f32_32x32x16_bf16 v[76:91], a[64:67], v[20:23], 0
    v_exp_f32 v60, v60
    v_exp_f32 v61, v61
    v_exp_f32 v62, v62
    v_exp_f32 v63, v63
    v_mfma_f32_32x32x16_bf16 v[76:91], a[68:71], v[24:27], v[76:91]
    ds_read_b64_tr_b16 a[182:183], v217 offset:512
    v_exp_f32 v64, v64
    v_exp_f32 v65, v65
    v_exp_f32 v66, v66
    v_exp_f32 v67, v67
    v_smfmac_f32_32x32x32_bf16 a[32:47], a[120:123], v[44:51], v11
    ds_read_b64_tr_b16 a[184:185], v216 offset:2048
    v_exp_f32 v68, v68
    v_exp_f32 v69, v69
    v_exp_f32 v70, v70
    v_exp_f32 v71, v71
    v_smfmac_f32_32x32x32_bf16 a[32:47], a[124:127], v[52:59], v11
    s_add_u32 m0, s59, 61440
    s_add_u32 s51, s99, 114688
    buffer_load_dwordx4 v188, s[20:23], s51 offen offset:0 lds
    buffer_load_dwordx4 v189, s[20:23], s51 offen offset:1024 lds
    ds_read_b64_tr_b16 a[186:187], v216 offset:2560
    v_exp_f32 v72, v72
    v_exp_f32 v73, v73
    v_exp_f32 v74, v74
    v_exp_f32 v75, v75
    v_mfma_f32_32x32x16_bf16 v[44:59], a[64:67], v[28:31], 0
    v_exp_f32 v76, v76
    v_exp_f32 v77, v77
    v_exp_f32 v78, v78
    v_exp_f32 v79, v79
    v_mfma_f32_32x32x16_bf16 v[44:59], a[68:71], v[32:35], v[44:59]
    ds_read_b64_tr_b16 a[188:189], v217 offset:2048
    v_exp_f32 v80, v80
    v_exp_f32 v81, v81
    v_exp_f32 v82, v82
    v_exp_f32 v83, v83
    v_smfmac_f32_32x32x32_bf16 v[196:211], a[120:123], v[60:67], v11
    ds_read_b64_tr_b16 a[190:191], v217 offset:2560
    v_exp_f32 v84, v84
    v_exp_f32 v85, v85
    v_exp_f32 v86, v86
    v_exp_f32 v87, v87
    v_smfmac_f32_32x32x32_bf16 v[196:211], a[124:127], v[68:75], v11
    buffer_load_dwordx4 a[112:115], v9, s[40:43], s52 offen sc1
    buffer_load_dwordx4 a[116:119], v9, s[40:43], s52 offen offset:1024 sc1
    buffer_load_dwordx4 a[120:123], v7, s[40:43], s52 offen sc1
    buffer_load_dwordx4 a[124:127], v8, s[40:43], s52 offen sc1
    s_add_u32 s52, s52, 57472
    v_exp_f32 v88, v88
    v_exp_f32 v89, v89
    v_exp_f32 v90, v90
    v_exp_f32 v91, v91
    v_mfma_f32_32x32x16_bf16 v[60:75], a[64:67], v[36:39], 0
    v_exp_f32 v44, v44
    v_exp_f32 v45, v45
    v_exp_f32 v46, v46
    v_exp_f32 v47, v47
    v_mfma_f32_32x32x16_bf16 v[60:75], a[68:71], v[40:43], v[60:75]
    v_exp_f32 v48, v48
    v_exp_f32 v49, v49
    v_exp_f32 v50, v50
    v_exp_f32 v51, v51
    v_smfmac_f32_32x32x32_bf16 a[0:15], a[72:75], v[76:83], v11
    v_exp_f32 v52, v52
    v_exp_f32 v53, v53
    v_exp_f32 v54, v54
    v_exp_f32 v55, v55
    v_smfmac_f32_32x32x32_bf16 a[0:15], a[76:79], v[84:91], v11
    buffer_load_dwordx4 v190, s[20:23], s51 offen offset:2048 lds
    buffer_load_dwordx4 v191, s[20:23], s51 offen offset:3072 lds
    v_exp_f32 v56, v56
    v_exp_f32 v57, v57
    v_exp_f32 v58, v58
    v_exp_f32 v59, v59
    v_mfma_f32_32x32x16_bf16 v[76:91], a[64:67], v[12:15], 0
    v_exp_f32 v60, v60
    v_exp_f32 v61, v61
    v_exp_f32 v62, v62
    v_exp_f32 v63, v63
    v_mfma_f32_32x32x16_bf16 v[76:91], a[68:71], v[16:19], v[76:91]
    s_waitcnt vmcnt(20)
    ds_read_b64_tr_b16 a[192:193], v216 offset:4096
    v_exp_f32 v64, v64
    v_exp_f32 v65, v65
    v_exp_f32 v66, v66
    v_exp_f32 v67, v67
    v_smfmac_f32_32x32x32_bf16 a[16:31], a[72:75], v[44:51], v11
    ds_read_b64_tr_b16 a[194:195], v216 offset:4608
    v_exp_f32 v68, v68
    v_exp_f32 v69, v69
    v_exp_f32 v70, v70
    v_exp_f32 v71, v71
    v_smfmac_f32_32x32x32_bf16 a[16:31], a[76:79], v[52:59], v11
    s_waitcnt lgkmcnt(2)
    s_add_u32 m0, s58, 0
    s_add_u32 s51, s100, 946176
    buffer_load_dwordx4 v184, s[28:31], s51 offen lds
    buffer_load_dwordx4 v185, s[28:31], s51 offen offset:1024 lds
    ds_read_b64_tr_b16 a[196:197], v217 offset:4096
    v_exp_f32 v72, v72
    v_exp_f32 v73, v73
    v_exp_f32 v74, v74
    v_exp_f32 v75, v75
    v_mfma_f32_32x32x16_bf16 v[44:59], a[80:83], v[20:23], 0
    v_exp_f32 v76, v76
    v_exp_f32 v77, v77
    v_exp_f32 v78, v78
    v_exp_f32 v79, v79
    v_mfma_f32_32x32x16_bf16 v[44:59], a[84:87], v[24:27], v[44:59]
    ds_read_b64_tr_b16 a[198:199], v217 offset:4608
    v_exp_f32 v80, v80
    v_exp_f32 v81, v81
    v_exp_f32 v82, v82
    v_exp_f32 v83, v83
    v_smfmac_f32_32x32x32_bf16 a[32:47], a[72:75], v[60:67], v11
    ds_read_b64_tr_b16 a[200:201], v216 offset:6144
    v_exp_f32 v84, v84
    v_exp_f32 v85, v85
    v_exp_f32 v86, v86
    v_exp_f32 v87, v87
    v_smfmac_f32_32x32x32_bf16 a[32:47], a[76:79], v[68:75], v11
    buffer_load_dwordx4 v186, s[28:31], s51 offen offset:2048 lds
    buffer_load_dwordx4 v187, s[28:31], s51 offen offset:3072 lds
    ds_read_b64_tr_b16 a[202:203], v216 offset:6656
    v_exp_f32 v88, v88
    v_exp_f32 v89, v89
    v_exp_f32 v90, v90
    v_exp_f32 v91, v91
    v_mfma_f32_32x32x16_bf16 v[60:75], a[80:83], v[28:31], 0
    v_exp_f32 v44, v44
    v_exp_f32 v45, v45
    v_exp_f32 v46, v46
    v_exp_f32 v47, v47
    v_mfma_f32_32x32x16_bf16 v[60:75], a[84:87], v[32:35], v[60:75]
    ds_read_b64_tr_b16 a[204:205], v217 offset:6144
    v_exp_f32 v48, v48
    v_exp_f32 v49, v49
    v_exp_f32 v50, v50
    v_exp_f32 v51, v51
    v_smfmac_f32_32x32x32_bf16 v[196:211], a[72:75], v[76:83], v11
    ds_read_b64_tr_b16 a[206:207], v217 offset:6656
    v_exp_f32 v52, v52
    v_exp_f32 v53, v53
    v_exp_f32 v54, v54
    v_exp_f32 v55, v55
    v_smfmac_f32_32x32x32_bf16 v[196:211], a[76:79], v[84:91], v11
    buffer_load_dwordx4 a[64:67], v9, s[40:43], s52 offen sc1
    buffer_load_dwordx4 a[68:71], v9, s[40:43], s52 offen offset:1024 sc1
    buffer_load_dwordx4 a[72:75], v7, s[40:43], s52 offen sc1
    buffer_load_dwordx4 a[76:79], v8, s[40:43], s52 offen sc1
    s_add_u32 s52, s52, 57472
    v_exp_f32 v56, v56
    v_exp_f32 v57, v57
    v_exp_f32 v58, v58
    v_exp_f32 v59, v59
    v_mfma_f32_32x32x16_bf16 v[76:91], a[80:83], v[36:39], 0
    v_exp_f32 v60, v60
    v_exp_f32 v61, v61
    v_exp_f32 v62, v62
    v_exp_f32 v63, v63
    v_mfma_f32_32x32x16_bf16 v[76:91], a[84:87], v[40:43], v[76:91]
    v_exp_f32 v64, v64
    v_exp_f32 v65, v65
    v_exp_f32 v66, v66
    v_exp_f32 v67, v67
    v_smfmac_f32_32x32x32_bf16 a[0:15], a[88:91], v[44:51], v11
    v_exp_f32 v68, v68
    v_exp_f32 v69, v69
    v_exp_f32 v70, v70
    v_exp_f32 v71, v71
    v_smfmac_f32_32x32x32_bf16 a[0:15], a[92:95], v[52:59], v11
    s_add_u32 m0, s59, 65536
    s_add_u32 s51, s99, 229376
    buffer_load_dwordx4 v188, s[20:23], s51 offen offset:0 lds
    buffer_load_dwordx4 v189, s[20:23], s51 offen offset:1024 lds
    v_exp_f32 v72, v72
    v_exp_f32 v73, v73
    v_exp_f32 v74, v74
    v_exp_f32 v75, v75
    v_mfma_f32_32x32x16_bf16 v[44:59], a[80:83], v[12:15], 0
    v_exp_f32 v76, v76
    v_exp_f32 v77, v77
    v_exp_f32 v78, v78
    v_exp_f32 v79, v79
    v_mfma_f32_32x32x16_bf16 v[44:59], a[84:87], v[16:19], v[44:59]
    v_exp_f32 v80, v80
    v_exp_f32 v81, v81
    v_exp_f32 v82, v82
    v_exp_f32 v83, v83
    v_smfmac_f32_32x32x32_bf16 a[16:31], a[88:91], v[60:67], v11
    v_exp_f32 v84, v84
    v_exp_f32 v85, v85
    v_exp_f32 v86, v86
    v_exp_f32 v87, v87
    v_smfmac_f32_32x32x32_bf16 a[16:31], a[92:95], v[68:75], v11
    buffer_load_dwordx4 v190, s[20:23], s51 offen offset:2048 lds
    buffer_load_dwordx4 v191, s[20:23], s51 offen offset:3072 lds
    v_exp_f32 v88, v88
    v_exp_f32 v89, v89
    v_exp_f32 v90, v90
    v_exp_f32 v91, v91
    s_waitcnt vmcnt(24)
    v_mfma_f32_32x32x16_bf16 v[60:75], a[96:99], v[20:23], 0
    v_exp_f32 v44, v44
    v_exp_f32 v45, v45
    v_exp_f32 v46, v46
    v_exp_f32 v47, v47
    v_mfma_f32_32x32x16_bf16 v[60:75], a[100:103], v[24:27], v[60:75]
    s_waitcnt vmcnt(20)
    ds_read_b64_tr_b16 a[208:209], v216 offset:8192
    v_exp_f32 v48, v48
    v_exp_f32 v49, v49
    v_exp_f32 v50, v50
    v_exp_f32 v51, v51
    v_smfmac_f32_32x32x32_bf16 a[32:47], a[88:91], v[76:83], v11
    ds_read_b64_tr_b16 a[210:211], v216 offset:8704
    v_exp_f32 v52, v52
    v_exp_f32 v53, v53
    v_exp_f32 v54, v54
    v_exp_f32 v55, v55
    v_smfmac_f32_32x32x32_bf16 a[32:47], a[92:95], v[84:91], v11
    s_waitcnt lgkmcnt(2)
    s_add_u32 m0, s58, 4096
    s_add_u32 s51, s100, 974848
    buffer_load_dwordx4 v184, s[28:31], s51 offen lds
    buffer_load_dwordx4 v185, s[28:31], s51 offen offset:1024 lds
    ds_read_b64_tr_b16 a[212:213], v217 offset:8192
    v_exp_f32 v56, v56
    v_exp_f32 v57, v57
    v_exp_f32 v58, v58
    v_exp_f32 v59, v59
    v_mfma_f32_32x32x16_bf16 v[76:91], a[96:99], v[28:31], 0
    v_exp_f32 v60, v60
    v_exp_f32 v61, v61
    v_exp_f32 v62, v62
    v_exp_f32 v63, v63
    v_mfma_f32_32x32x16_bf16 v[76:91], a[100:103], v[32:35], v[76:91]
    ds_read_b64_tr_b16 a[214:215], v217 offset:8704
    v_exp_f32 v64, v64
    v_exp_f32 v65, v65
    v_exp_f32 v66, v66
    v_exp_f32 v67, v67
    v_smfmac_f32_32x32x32_bf16 v[196:211], a[88:91], v[44:51], v11
    ds_read_b64_tr_b16 a[216:217], v216 offset:10240
    v_exp_f32 v68, v68
    v_exp_f32 v69, v69
    v_exp_f32 v70, v70
    v_exp_f32 v71, v71
    v_smfmac_f32_32x32x32_bf16 v[196:211], a[92:95], v[52:59], v11
    buffer_load_dwordx4 a[80:83], v9, s[40:43], s52 offen sc1
    buffer_load_dwordx4 a[84:87], v9, s[40:43], s52 offen offset:1024 sc1
    buffer_load_dwordx4 a[88:91], v7, s[40:43], s52 offen sc1
    buffer_load_dwordx4 a[92:95], v8, s[40:43], s52 offen sc1
    s_add_u32 s52, s52, 57472
    ds_read_b64_tr_b16 a[218:219], v216 offset:10752
    v_exp_f32 v72, v72
    v_exp_f32 v73, v73
    v_exp_f32 v74, v74
    v_exp_f32 v75, v75
    v_mfma_f32_32x32x16_bf16 v[44:59], a[96:99], v[36:39], 0
    v_exp_f32 v76, v76
    v_exp_f32 v77, v77
    v_exp_f32 v78, v78
    v_exp_f32 v79, v79
    v_mfma_f32_32x32x16_bf16 v[44:59], a[100:103], v[40:43], v[44:59]
    ds_read_b64_tr_b16 a[220:221], v217 offset:10240
    v_exp_f32 v80, v80
    v_exp_f32 v81, v81
    v_exp_f32 v82, v82
    v_exp_f32 v83, v83
    v_smfmac_f32_32x32x32_bf16 a[0:15], a[104:107], v[60:67], v11
    ds_read_b64_tr_b16 a[222:223], v217 offset:10752
    v_exp_f32 v84, v84
    v_exp_f32 v85, v85
    v_exp_f32 v86, v86
    v_exp_f32 v87, v87
    v_smfmac_f32_32x32x32_bf16 a[0:15], a[108:111], v[68:75], v11
    buffer_load_dwordx4 v186, s[28:31], s51 offen offset:2048 lds
    buffer_load_dwordx4 v187, s[28:31], s51 offen offset:3072 lds
    v_exp_f32 v88, v88
    v_exp_f32 v89, v89
    v_exp_f32 v90, v90
    v_exp_f32 v91, v91
    v_mfma_f32_32x32x16_bf16 v[60:75], a[96:99], v[12:15], 0
    v_exp_f32 v44, v44
    v_exp_f32 v45, v45
    v_exp_f32 v46, v46
    v_exp_f32 v47, v47
    v_mfma_f32_32x32x16_bf16 v[60:75], a[100:103], v[16:19], v[60:75]
    v_exp_f32 v48, v48
    v_exp_f32 v49, v49
    v_exp_f32 v50, v50
    v_exp_f32 v51, v51
    v_smfmac_f32_32x32x32_bf16 a[16:31], a[104:107], v[76:83], v11
    v_exp_f32 v52, v52
    v_exp_f32 v53, v53
    v_exp_f32 v54, v54
    v_exp_f32 v55, v55
    v_smfmac_f32_32x32x32_bf16 a[16:31], a[108:111], v[84:91], v11
    s_add_u32 m0, s59, 69632
    s_add_u32 s51, s99, 344064
    buffer_load_dwordx4 v188, s[20:23], s51 offen offset:0 lds
    buffer_load_dwordx4 v189, s[20:23], s51 offen offset:1024 lds
    v_exp_f32 v56, v56
    v_exp_f32 v57, v57
    v_exp_f32 v58, v58
    v_exp_f32 v59, v59
    s_waitcnt vmcnt(24)
    v_mfma_f32_32x32x16_bf16 v[76:91], a[112:115], v[20:23], 0
    v_exp_f32 v60, v60
    v_exp_f32 v61, v61
    v_exp_f32 v62, v62
    v_exp_f32 v63, v63
    v_mfma_f32_32x32x16_bf16 v[76:91], a[116:119], v[24:27], v[76:91]
    v_exp_f32 v64, v64
    v_exp_f32 v65, v65
    v_exp_f32 v66, v66
    v_exp_f32 v67, v67
    v_smfmac_f32_32x32x32_bf16 a[32:47], a[104:107], v[44:51], v11
    v_exp_f32 v68, v68
    v_exp_f32 v69, v69
    v_exp_f32 v70, v70
    v_exp_f32 v71, v71
    v_smfmac_f32_32x32x32_bf16 a[32:47], a[108:111], v[52:59], v11
    v_exp_f32 v72, v72
    v_exp_f32 v73, v73
    v_exp_f32 v74, v74
    v_exp_f32 v75, v75
    v_mfma_f32_32x32x16_bf16 v[44:59], a[112:115], v[28:31], 0
    v_exp_f32 v76, v76
    v_exp_f32 v77, v77
    v_exp_f32 v78, v78
    v_exp_f32 v79, v79
    v_mfma_f32_32x32x16_bf16 v[44:59], a[116:119], v[32:35], v[44:59]
    s_waitcnt vmcnt(18)
    ds_read_b64_tr_b16 a[224:225], v216 offset:0
    v_exp_f32 v80, v80
    v_exp_f32 v81, v81
    v_exp_f32 v82, v82
    v_exp_f32 v83, v83
    v_smfmac_f32_32x32x32_bf16 v[196:211], a[104:107], v[60:67], v11
    ds_read_b64_tr_b16 a[226:227], v216 offset:512
    v_exp_f32 v84, v84
    v_exp_f32 v85, v85
    v_exp_f32 v86, v86
    v_exp_f32 v87, v87
    v_smfmac_f32_32x32x32_bf16 v[196:211], a[108:111], v[68:75], v11
    buffer_load_dwordx4 a[96:99], v9, s[40:43], s52 offen sc1
    buffer_load_dwordx4 a[100:103], v9, s[40:43], s52 offen offset:1024 sc1
    buffer_load_dwordx4 a[104:107], v7, s[40:43], s52 offen sc1
    buffer_load_dwordx4 a[108:111], v8, s[40:43], s52 offen sc1
    s_add_u32 s52, s52, 57472
    ds_read_b64_tr_b16 a[228:229], v217 offset:0
    v_exp_f32 v88, v88
    v_exp_f32 v89, v89
    v_exp_f32 v90, v90
    v_exp_f32 v91, v91
    v_mfma_f32_32x32x16_bf16 v[60:75], a[112:115], v[36:39], 0
    v_exp_f32 v44, v44
    v_exp_f32 v45, v45
    v_exp_f32 v46, v46
    v_exp_f32 v47, v47
    v_mfma_f32_32x32x16_bf16 v[60:75], a[116:119], v[40:43], v[60:75]
    ds_read_b64_tr_b16 a[230:231], v217 offset:512
    v_exp_f32 v48, v48
    v_exp_f32 v49, v49
    v_exp_f32 v50, v50
    v_exp_f32 v51, v51
    v_smfmac_f32_32x32x32_bf16 a[0:15], a[120:123], v[76:83], v11
    ds_read_b64_tr_b16 a[232:233], v216 offset:2048
    v_exp_f32 v52, v52
    v_exp_f32 v53, v53
    v_exp_f32 v54, v54
    v_exp_f32 v55, v55
    v_smfmac_f32_32x32x32_bf16 a[0:15], a[124:127], v[84:91], v11
    ds_read_b64_tr_b16 a[234:235], v216 offset:2560
    v_exp_f32 v56, v56
    v_exp_f32 v57, v57
    v_exp_f32 v58, v58
    v_exp_f32 v59, v59
    v_mfma_f32_32x32x16_bf16 v[76:91], a[112:115], v[12:15], 0
    v_exp_f32 v60, v60
    v_exp_f32 v61, v61
    v_exp_f32 v62, v62
    v_exp_f32 v63, v63
    v_mfma_f32_32x32x16_bf16 v[76:91], a[116:119], v[16:19], v[76:91]
    ds_read_b64_tr_b16 a[236:237], v217 offset:2048
    v_exp_f32 v64, v64
    v_exp_f32 v65, v65
    v_exp_f32 v66, v66
    v_exp_f32 v67, v67
    v_smfmac_f32_32x32x32_bf16 a[16:31], a[120:123], v[44:51], v11
    ds_read_b64_tr_b16 a[238:239], v217 offset:2560
    v_exp_f32 v68, v68
    v_exp_f32 v69, v69
    v_exp_f32 v70, v70
    v_exp_f32 v71, v71
    v_smfmac_f32_32x32x32_bf16 a[16:31], a[124:127], v[52:59], v11
    v_exp_f32 v72, v72
    v_exp_f32 v73, v73
    v_exp_f32 v74, v74
    v_exp_f32 v75, v75
    s_waitcnt vmcnt(18)
    v_mfma_f32_32x32x16_bf16 v[44:59], a[64:67], v[20:23], 0
    v_exp_f32 v76, v76
    v_exp_f32 v77, v77
    v_exp_f32 v78, v78
    v_exp_f32 v79, v79
    v_mfma_f32_32x32x16_bf16 v[44:59], a[68:71], v[24:27], v[44:59]
    v_exp_f32 v80, v80
    v_exp_f32 v81, v81
    v_exp_f32 v82, v82
    v_exp_f32 v83, v83
    v_smfmac_f32_32x32x32_bf16 a[32:47], a[120:123], v[60:67], v11
    v_exp_f32 v84, v84
    v_exp_f32 v85, v85
    v_exp_f32 v86, v86
    v_exp_f32 v87, v87
    v_smfmac_f32_32x32x32_bf16 a[32:47], a[124:127], v[68:75], v11
    v_exp_f32 v88, v88
    v_exp_f32 v89, v89
    v_exp_f32 v90, v90
    v_exp_f32 v91, v91
    v_mfma_f32_32x32x16_bf16 v[60:75], a[64:67], v[28:31], 0
    v_exp_f32 v44, v44
    v_exp_f32 v45, v45
    v_exp_f32 v46, v46
    v_exp_f32 v47, v47
    v_mfma_f32_32x32x16_bf16 v[60:75], a[68:71], v[32:35], v[60:75]
    v_exp_f32 v48, v48
    v_exp_f32 v49, v49
    v_exp_f32 v50, v50
    v_exp_f32 v51, v51
    v_smfmac_f32_32x32x32_bf16 v[196:211], a[120:123], v[76:83], v11
    v_exp_f32 v52, v52
    v_exp_f32 v53, v53
    v_exp_f32 v54, v54
    v_exp_f32 v55, v55
    v_smfmac_f32_32x32x32_bf16 v[196:211], a[124:127], v[84:91], v11
    buffer_load_dwordx4 a[112:115], v9, s[40:43], s52 offen sc1
    buffer_load_dwordx4 a[116:119], v9, s[40:43], s52 offen offset:1024 sc1
    buffer_load_dwordx4 a[120:123], v7, s[40:43], s52 offen sc1
    buffer_load_dwordx4 a[124:127], v8, s[40:43], s52 offen sc1
    s_add_u32 s52, s52, 57472
    v_exp_f32 v56, v56
    v_exp_f32 v57, v57
    v_exp_f32 v58, v58
    v_exp_f32 v59, v59
    v_mfma_f32_32x32x16_bf16 v[76:91], a[64:67], v[36:39], 0
    v_exp_f32 v60, v60
    v_exp_f32 v61, v61
    v_exp_f32 v62, v62
    v_exp_f32 v63, v63
    v_mfma_f32_32x32x16_bf16 v[76:91], a[68:71], v[40:43], v[76:91]
    v_exp_f32 v64, v64
    v_exp_f32 v65, v65
    v_exp_f32 v66, v66
    v_exp_f32 v67, v67
    v_smfmac_f32_32x32x32_bf16 a[0:15], a[72:75], v[44:51], v11
    v_exp_f32 v68, v68
    v_exp_f32 v69, v69
    v_exp_f32 v70, v70
    v_exp_f32 v71, v71
    v_smfmac_f32_32x32x32_bf16 a[0:15], a[76:79], v[52:59], v11
    v_exp_f32 v72, v72
    v_exp_f32 v73, v73
    v_exp_f32 v74, v74
    v_exp_f32 v75, v75
    v_mfma_f32_32x32x16_bf16 v[44:59], a[64:67], v[12:15], 0
    v_exp_f32 v76, v76
    v_exp_f32 v77, v77
    v_exp_f32 v78, v78
    v_exp_f32 v79, v79
    v_mfma_f32_32x32x16_bf16 v[44:59], a[68:71], v[16:19], v[44:59]
    s_waitcnt vmcnt(10)
    ds_read_b64_tr_b16 a[240:241], v216 offset:4096
    v_exp_f32 v80, v80
    v_exp_f32 v81, v81
    v_exp_f32 v82, v82
    v_exp_f32 v83, v83
    v_smfmac_f32_32x32x32_bf16 a[16:31], a[72:75], v[60:67], v11
    ds_read_b64_tr_b16 a[242:243], v216 offset:4608
    v_exp_f32 v84, v84
    v_exp_f32 v85, v85
    v_exp_f32 v86, v86
    v_exp_f32 v87, v87
    v_smfmac_f32_32x32x32_bf16 a[16:31], a[76:79], v[68:75], v11
    ds_read_b64_tr_b16 a[244:245], v217 offset:4096
    v_exp_f32 v88, v88
    v_exp_f32 v89, v89
    v_exp_f32 v90, v90
    v_exp_f32 v91, v91
    v_mfma_f32_32x32x16_bf16 v[60:75], a[80:83], v[20:23], 0
    v_exp_f32 v44, v44
    v_exp_f32 v45, v45
    v_exp_f32 v46, v46
    v_exp_f32 v47, v47
    v_mfma_f32_32x32x16_bf16 v[60:75], a[84:87], v[24:27], v[60:75]
    ds_read_b64_tr_b16 a[246:247], v217 offset:4608
    v_exp_f32 v48, v48
    v_exp_f32 v49, v49
    v_exp_f32 v50, v50
    v_exp_f32 v51, v51
    v_smfmac_f32_32x32x32_bf16 a[32:47], a[72:75], v[76:83], v11
    ds_read_b64_tr_b16 a[248:249], v216 offset:6144
    v_exp_f32 v52, v52
    v_exp_f32 v53, v53
    v_exp_f32 v54, v54
    v_exp_f32 v55, v55
    v_smfmac_f32_32x32x32_bf16 a[32:47], a[76:79], v[84:91], v11
    ds_read_b64_tr_b16 a[250:251], v216 offset:6656
    v_exp_f32 v56, v56
    v_exp_f32 v57, v57
    v_exp_f32 v58, v58
    v_exp_f32 v59, v59
    v_mfma_f32_32x32x16_bf16 v[76:91], a[80:83], v[28:31], 0
    v_exp_f32 v60, v60
    v_exp_f32 v61, v61
    v_exp_f32 v62, v62
    v_exp_f32 v63, v63
    v_mfma_f32_32x32x16_bf16 v[76:91], a[84:87], v[32:35], v[76:91]
    ds_read_b64_tr_b16 a[252:253], v217 offset:6144
    v_exp_f32 v64, v64
    v_exp_f32 v65, v65
    v_exp_f32 v66, v66
    v_exp_f32 v67, v67
    v_smfmac_f32_32x32x32_bf16 v[196:211], a[72:75], v[44:51], v11
    ds_read_b64_tr_b16 a[254:255], v217 offset:6656
    v_exp_f32 v68, v68
    v_exp_f32 v69, v69
    v_exp_f32 v70, v70
    v_exp_f32 v71, v71
    v_smfmac_f32_32x32x32_bf16 v[196:211], a[76:79], v[52:59], v11
    buffer_load_dwordx4 v[140:143], v212, s[8:11], 0 offen
    buffer_load_dwordx4 v[144:147], v212, s[8:11], 0 offen offset:32
    v_exp_f32 v72, v72
    v_exp_f32 v73, v73
    v_exp_f32 v74, v74
    v_exp_f32 v75, v75
    v_mfma_f32_32x32x16_bf16 v[44:59], a[80:83], v[36:39], 0
    v_exp_f32 v76, v76
    v_exp_f32 v77, v77
    v_exp_f32 v78, v78
    v_exp_f32 v79, v79
    v_mfma_f32_32x32x16_bf16 v[44:59], a[84:87], v[40:43], v[44:59]
    v_exp_f32 v80, v80
    v_exp_f32 v81, v81
    v_exp_f32 v82, v82
    v_exp_f32 v83, v83
    v_smfmac_f32_32x32x32_bf16 a[0:15], a[88:91], v[60:67], v11
    v_exp_f32 v84, v84
    v_exp_f32 v85, v85
    v_exp_f32 v86, v86
    v_exp_f32 v87, v87
    v_smfmac_f32_32x32x32_bf16 a[0:15], a[92:95], v[68:75], v11
    buffer_load_dwordx4 v[156:159], v213, s[32:35], 0 offen
    buffer_load_dwordx4 v[160:163], v213, s[32:35], 0 offen offset:32
    v_exp_f32 v88, v88
    v_exp_f32 v89, v89
    v_exp_f32 v90, v90
    v_exp_f32 v91, v91
    v_mfma_f32_32x32x16_bf16 v[60:75], a[80:83], v[12:15], 0
    v_exp_f32 v44, v44
    v_exp_f32 v45, v45
    v_exp_f32 v46, v46
    v_exp_f32 v47, v47
    v_mfma_f32_32x32x16_bf16 v[60:75], a[84:87], v[16:19], v[60:75]
    v_exp_f32 v48, v48
    v_exp_f32 v49, v49
    v_exp_f32 v50, v50
    v_exp_f32 v51, v51
    v_smfmac_f32_32x32x32_bf16 a[16:31], a[88:91], v[76:83], v11
    v_exp_f32 v52, v52
    v_exp_f32 v53, v53
    v_exp_f32 v54, v54
    v_exp_f32 v55, v55
    v_smfmac_f32_32x32x32_bf16 a[16:31], a[92:95], v[84:91], v11
    v_and_b32 v215, 15, v1
    v_lshlrev_b32 v215, 7, v215
    buffer_load_dwordx2 v[248:249], v215, s[40:43], s97 offen sc1
    v_exp_f32 v56, v56
    v_exp_f32 v57, v57
    v_exp_f32 v58, v58
    v_exp_f32 v59, v59
    s_waitcnt vmcnt(9)
    v_mfma_f32_32x32x16_bf16 v[76:91], a[96:99], v[20:23], 0
    v_exp_f32 v60, v60
    v_exp_f32 v61, v61
    v_exp_f32 v62, v62
    v_exp_f32 v63, v63
    v_mfma_f32_32x32x16_bf16 v[76:91], a[100:103], v[24:27], v[76:91]
    v_exp_f32 v64, v64
    v_exp_f32 v65, v65
    v_exp_f32 v66, v66
    v_exp_f32 v67, v67
    v_smfmac_f32_32x32x32_bf16 a[32:47], a[88:91], v[44:51], v11
    v_exp_f32 v68, v68
    v_exp_f32 v69, v69
    v_exp_f32 v70, v70
    v_exp_f32 v71, v71
    v_smfmac_f32_32x32x32_bf16 a[32:47], a[92:95], v[52:59], v11
    v_add_u32 v5, 114688, v192
    v_add_u32 v6, 114688, v193
    v_add_u32 v3, 114688, v194
    v_add_u32 v4, s58, v2
    v_exp_f32 v72, v72
    v_exp_f32 v73, v73
    v_exp_f32 v74, v74
    v_exp_f32 v75, v75
    v_mfma_f32_32x32x16_bf16 v[44:59], a[96:99], v[28:31], 0
    v_exp_f32 v76, v76
    v_exp_f32 v77, v77
    v_exp_f32 v78, v78
    v_exp_f32 v79, v79
    v_mfma_f32_32x32x16_bf16 v[44:59], a[100:103], v[32:35], v[44:59]
    v_exp_f32 v80, v80
    v_exp_f32 v81, v81
    v_exp_f32 v82, v82
    v_exp_f32 v83, v83
    v_smfmac_f32_32x32x32_bf16 v[196:211], a[88:91], v[60:67], v11
    v_exp_f32 v84, v84
    v_exp_f32 v85, v85
    v_exp_f32 v86, v86
    v_exp_f32 v87, v87
    v_smfmac_f32_32x32x32_bf16 v[196:211], a[92:95], v[68:75], v11
    s_lshl_b32 s48, s57, 2
    s_add_u32 s48, s48, s44
    s_lshl_b32 s48, s48, 4
    s_add_u32 s48, s48, s56
    s_lshl_b32 s49, s48, 7
    s_add_u32 s49, s49, 18350080
    s_lshl_b32 s48, s48, 11
    s_add_u32 s48, s48, 6291456
    v_exp_f32 v88, v88
    v_exp_f32 v89, v89
    v_exp_f32 v90, v90
    v_exp_f32 v91, v91
    v_mfma_f32_32x32x16_bf16 v[60:75], a[96:99], v[36:39], 0
    v_exp_f32 v44, v44
    v_exp_f32 v45, v45
    v_exp_f32 v46, v46
    v_exp_f32 v47, v47
    v_mfma_f32_32x32x16_bf16 v[60:75], a[100:103], v[40:43], v[60:75]
    v_exp_f32 v48, v48
    v_exp_f32 v49, v49
    v_exp_f32 v50, v50
    v_exp_f32 v51, v51
    v_smfmac_f32_32x32x32_bf16 a[0:15], a[104:107], v[76:83], v11
    v_exp_f32 v52, v52
    v_exp_f32 v53, v53
    v_exp_f32 v54, v54
    v_exp_f32 v55, v55
    v_smfmac_f32_32x32x32_bf16 a[0:15], a[108:111], v[84:91], v11
    v_exp_f32 v56, v56
    v_exp_f32 v57, v57
    v_exp_f32 v58, v58
    v_exp_f32 v59, v59
    v_mfma_f32_32x32x16_bf16 v[76:91], a[96:99], v[12:15], 0
    v_exp_f32 v60, v60
    v_exp_f32 v61, v61
    v_exp_f32 v62, v62
    v_exp_f32 v63, v63
    v_mfma_f32_32x32x16_bf16 v[76:91], a[100:103], v[16:19], v[76:91]
    v_exp_f32 v64, v64
    v_exp_f32 v65, v65
    v_exp_f32 v66, v66
    v_exp_f32 v67, v67
    v_smfmac_f32_32x32x32_bf16 a[16:31], a[104:107], v[44:51], v11
    v_exp_f32 v68, v68
    v_exp_f32 v69, v69
    v_exp_f32 v70, v70
    v_exp_f32 v71, v71
    v_smfmac_f32_32x32x32_bf16 a[16:31], a[108:111], v[52:59], v11
    v_exp_f32 v72, v72
    v_exp_f32 v73, v73
    v_exp_f32 v74, v74
    v_exp_f32 v75, v75
    s_waitcnt vmcnt(5)
    v_mfma_f32_32x32x16_bf16 v[44:59], a[112:115], v[20:23], 0
    v_exp_f32 v76, v76
    v_exp_f32 v77, v77
    v_exp_f32 v78, v78
    v_exp_f32 v79, v79
    v_mfma_f32_32x32x16_bf16 v[44:59], a[116:119], v[24:27], v[44:59]
    v_exp_f32 v80, v80
    v_exp_f32 v81, v81
    v_exp_f32 v82, v82
    v_exp_f32 v83, v83
    v_smfmac_f32_32x32x32_bf16 a[32:47], a[104:107], v[60:67], v11
    v_exp_f32 v84, v84
    v_exp_f32 v85, v85
    v_exp_f32 v86, v86
    v_exp_f32 v87, v87
    v_smfmac_f32_32x32x32_bf16 a[32:47], a[108:111], v[68:75], v11
    v_exp_f32 v88, v88
    v_exp_f32 v89, v89
    v_exp_f32 v90, v90
    v_exp_f32 v91, v91
    v_mfma_f32_32x32x16_bf16 v[60:75], a[112:115], v[28:31], 0
    v_exp_f32 v44, v44
    v_exp_f32 v45, v45
    v_exp_f32 v46, v46
    v_exp_f32 v47, v47
    v_mfma_f32_32x32x16_bf16 v[60:75], a[116:119], v[32:35], v[60:75]
    v_exp_f32 v48, v48
    v_exp_f32 v49, v49
    v_exp_f32 v50, v50
    v_exp_f32 v51, v51
    v_smfmac_f32_32x32x32_bf16 v[196:211], a[104:107], v[76:83], v11
    v_exp_f32 v52, v52
    v_exp_f32 v53, v53
    v_exp_f32 v54, v54
    v_exp_f32 v55, v55
    v_smfmac_f32_32x32x32_bf16 v[196:211], a[108:111], v[84:91], v11
    s_waitcnt lgkmcnt(0)
    s_barrier
    v_exp_f32 v56, v56
    v_exp_f32 v57, v57
    v_exp_f32 v58, v58
    v_exp_f32 v59, v59
    v_mfma_f32_32x32x16_bf16 v[76:91], a[112:115], v[36:39], 0
    v_exp_f32 v60, v60
    v_exp_f32 v61, v61
    v_exp_f32 v62, v62
    v_exp_f32 v63, v63
    v_mfma_f32_32x32x16_bf16 v[76:91], a[116:119], v[40:43], v[76:91]
    v_exp_f32 v64, v64
    v_exp_f32 v65, v65
    v_exp_f32 v66, v66
    v_exp_f32 v67, v67
    v_smfmac_f32_32x32x32_bf16 a[0:15], a[120:123], v[44:51], v11
    v_exp_f32 v68, v68
    v_exp_f32 v69, v69
    v_exp_f32 v70, v70
    v_exp_f32 v71, v71
    v_smfmac_f32_32x32x32_bf16 a[0:15], a[124:127], v[52:59], v11
    v_exp_f32 v72, v72
    v_exp_f32 v73, v73
    v_exp_f32 v74, v74
    v_exp_f32 v75, v75
    v_mfma_f32_32x32x16_bf16 v[44:59], a[112:115], v[12:15], 0
    v_exp_f32 v76, v76
    v_exp_f32 v77, v77
    v_exp_f32 v78, v78
    v_exp_f32 v79, v79
    v_mfma_f32_32x32x16_bf16 v[44:59], a[116:119], v[16:19], v[44:59]
    s_nop 1
    ds_write_b128 v5, a[0:3] offset:0
    v_exp_f32 v80, v80
    v_exp_f32 v81, v81
    v_exp_f32 v82, v82
    v_exp_f32 v83, v83
    v_smfmac_f32_32x32x32_bf16 a[16:31], a[120:123], v[60:67], v11
    ds_write_b128 v5, a[4:7] offset:1024
    v_exp_f32 v84, v84
    v_exp_f32 v85, v85
    v_exp_f32 v86, v86
    v_exp_f32 v87, v87
    v_smfmac_f32_32x32x32_bf16 a[16:31], a[124:127], v[68:75], v11
    ds_write_b128 v5, a[8:11] offset:2048
    v_exp_f32 v88, v88
    v_exp_f32 v89, v89
    v_exp_f32 v90, v90
    v_exp_f32 v91, v91
    ds_write_b128 v5, a[12:15] offset:3072
    v_exp_f32 v44, v44
    v_exp_f32 v45, v45
    v_exp_f32 v46, v46
    v_exp_f32 v47, v47
    s_nop 1
    ds_write_b128 v6, a[16:19] offset:0
    v_exp_f32 v48, v48
    v_exp_f32 v49, v49
    v_exp_f32 v50, v50
    v_exp_f32 v51, v51
    v_smfmac_f32_32x32x32_bf16 a[32:47], a[120:123], v[76:83], v11
    ds_write_b128 v6, a[20:23] offset:1024
    v_exp_f32 v52, v52
    v_exp_f32 v53, v53
    v_exp_f32 v54, v54
    v_exp_f32 v55, v55
    v_smfmac_f32_32x32x32_bf16 a[32:47], a[124:127], v[84:91], v11
    ds_write_b128 v6, a[24:27] offset:2048
    v_exp_f32 v56, v56
    v_exp_f32 v57, v57
    v_exp_f32 v58, v58
    v_exp_f32 v59, v59
    ds_write_b128 v6, a[28:31] offset:3072
    v_smfmac_f32_32x32x32_bf16 v[196:211], a[120:123], v[44:51], v11
    v_smfmac_f32_32x32x32_bf16 v[196:211], a[124:127], v[52:59], v11
    s_nop 3
    ds_write_b128 v3, a[32:35] offset:0
    ds_write_b128 v3, a[36:39] offset:1024
    ds_write_b128 v3, a[40:43] offset:2048
    ds_write_b128 v3, a[44:47] offset:3072
    s_waitcnt vmcnt(0)
    v_cmp_ne_u64 vcc, v[254:255], v[248:249]
    s_nop 0
    s_cmp_eq_u64 vcc, 0
    s_cselect_b32 s26, 0x01220000, 0
    s_cselect_b32 s6, 0, 0x01220000
    s_mov_b32 s50, 0x21800000
    s_mov_b32 s51, 0x5d800000
    s_waitcnt vmcnt(0) lgkmcnt(0)
    s_barrier
    ds_read_b128 v[104:107], v4 offset:3072
    ds_read_b128 v[120:123], v4 offset:7168
    ds_read_b128 v[136:139], v4 offset:11264
    ds_read_b128 v[92:95], v4 offset:0
    ds_read_b128 v[108:111], v4 offset:4096
    ds_read_b128 v[124:127], v4 offset:8192
    ds_read_b128 v[96:99], v4 offset:1024
    ds_read_b128 v[112:115], v4 offset:5120
    ds_read_b128 v[128:131], v4 offset:9216
    ds_read_b128 v[100:103], v4 offset:2048
    ds_read_b128 v[116:119], v4 offset:6144
    ds_read_b128 v[132:135], v4 offset:10240
    s_waitcnt lgkmcnt(11)
    v_pk_add_f32 v[208:209], v[208:209], v[104:105]
    v_pk_add_f32 v[210:211], v[210:211], v[106:107]
    s_waitcnt lgkmcnt(10)
    v_pk_add_f32 v[208:209], v[208:209], v[120:121]
    v_pk_add_f32 v[210:211], v[210:211], v[122:123]
    s_waitcnt lgkmcnt(9)
    v_pk_add_f32 v[208:209], v[208:209], v[136:137]
    v_pk_add_f32 v[210:211], v[210:211], v[138:139]
    v_mov_b32 v3, v208
    v_mov_b32 v4, v208
    s_waitcnt lgkmcnt(8)
    v_pk_add_f32 v[196:197], v[196:197], v[92:93]
    v_pk_add_f32 v[198:199], v[198:199], v[94:95]
    s_waitcnt lgkmcnt(7)
    v_pk_add_f32 v[196:197], v[196:197], v[108:109]
    v_pk_add_f32 v[198:199], v[198:199], v[110:111]
    s_waitcnt lgkmcnt(6)
    v_pk_add_f32 v[196:197], v[196:197], v[124:125]
    v_pk_add_f32 v[198:199], v[198:199], v[126:127]
    v_permlane32_swap_b32 v3, v4
    s_waitcnt lgkmcnt(5)
    v_pk_add_f32 v[200:201], v[200:201], v[96:97]
    v_pk_add_f32 v[202:203], v[202:203], v[98:99]
    s_waitcnt lgkmcnt(4)
    v_pk_add_f32 v[200:201], v[200:201], v[112:113]
    v_pk_add_f32 v[202:203], v[202:203], v[114:115]
    s_waitcnt lgkmcnt(3)
    v_pk_add_f32 v[200:201], v[200:201], v[128:129]
    v_pk_add_f32 v[202:203], v[202:203], v[130:131]
    v_cmp_nle_f32 vcc, s50, v4
    v_cmp_nge_f32 s[14:15], s51, v4
    s_waitcnt lgkmcnt(2)
    v_pk_add_f32 v[204:205], v[204:205], v[100:101]
    v_pk_add_f32 v[206:207], v[206:207], v[102:103]
    s_waitcnt lgkmcnt(1)
    v_pk_add_f32 v[204:205], v[204:205], v[116:117]
    v_pk_add_f32 v[206:207], v[206:207], v[118:119]
    s_waitcnt lgkmcnt(0)
    v_pk_add_f32 v[204:205], v[204:205], v[132:133]
    v_pk_add_f32 v[206:207], v[206:207], v[134:135]
    s_mov_b32 s50, 0x7f7fffff
    s_or_b64 vcc, vcc, s[14:15]
    v_max3_f32 v5, |v196|, |v197|, |v198|
    v_max3_f32 v5, v5, |v199|, |v200|
    v_max3_f32 v5, v5, |v201|, |v202|
    v_max3_f32 v5, v5, |v203|, |v204|
    v_max3_f32 v5, v5, |v205|, |v206|
    v_max3_f32 v5, v5, |v207|, |v208|
    v_max3_f32 v5, v5, |v209|, |v210|
    v_max_f32 v5, v5, |v211|
    v_cmp_nge_f32 s[14:15], s50, v5
    s_nop 0
    s_or_b64 vcc, vcc, s[14:15]
    s_cbranch_scc1 L_slow
L_slow_ret:
    v_rcp_f32 v4, v4
    v_cmp_lt_u32 vcc, 31, v1
    v_pk_mul_f32 v[196:197], v[196:197], v[4:5] op_sel_hi:[1,0]
    v_pk_mul_f32 v[198:199], v[198:199], v[4:5] op_sel_hi:[1,0]
    v_pk_mul_f32 v[200:201], v[200:201], v[4:5] op_sel_hi:[1,0]
    v_pk_mul_f32 v[202:203], v[202:203], v[4:5] op_sel_hi:[1,0]
    v_cvt_pk_bf16_f32 v196, v196, v197
    v_cvt_pk_bf16_f32 v197, v198, v199
    v_cvt_pk_bf16_f32 v198, v200, v201
    v_cvt_pk_bf16_f32 v199, v202, v203
    buffer_store_dwordx4 v[196:199], v2, s[40:43], s48 offen offset:0 sc1
    v_pk_mul_f32 v[204:205], v[204:205], v[4:5] op_sel_hi:[1,0]
    v_pk_mul_f32 v[206:207], v[206:207], v[4:5] op_sel_hi:[1,0]
    v_pk_mul_f32 v[208:209], v[208:209], v[4:5] op_sel_hi:[1,0]
    v_pk_mul_f32 v[210:211], v[210:211], v[4:5] op_sel_hi:[1,0]
    v_cvt_pk_bf16_f32 v204, v204, v205
    v_cvt_pk_bf16_f32 v205, v206, v207
    v_cvt_pk_bf16_f32 v206, v208, v209
    v_cvt_pk_bf16_f32 v207, v210, v211
    v_cndmask_b32 v206, v206, 0, vcc
    v_cndmask_b32 v207, v207, 0, vcc
    buffer_store_dwordx4 v[204:207], v2, s[40:43], s48 offen offset:1024 sc1
    s_cmp_lt_u32 s47, 14
    s_cbranch_scc1 L_cont
    s_waitcnt vmcnt(0)
    s_mov_b64 exec, 1
    buffer_store_dword v254, v10, s[40:43], s49 offen sc1
    s_mov_b64 exec, -1
    s_cmp_lg_u32 s2, 255
    s_cbranch_scc1 L_end
    s_lshl_b32 s48, s44, 13
    s_add_u32 s48, s48, 18907136
    s_mov_b32 s54, 0x40000
L_pollX_3:
    buffer_load_dword v215, v251, s[40:43], s48 offen sc1
    s_sub_u32 s54, s54, 1
    s_waitcnt vmcnt(0)
    s_cbranch_scc1 L_pollX_3_x
    v_cmp_ne_u32 vcc, s101, v215
    s_nop 0
    s_cbranch_vccnz L_pollX_3
L_pollX_3_x:
    s_barrier
    s_cmp_lg_u32 s44, 0
    s_cbranch_scc1 L_end
    s_mov_b32 s48, 18939904
    s_mov_b64 exec, 1
    buffer_store_dword v254, v10, s[40:43], s48 offen sc1
    s_mov_b64 exec, -1
    s_branch L_end
L_cont:
    s_add_u32 m0, s58, 0
    s_add_u32 s51, s100, 0
    buffer_load_dwordx4 v184, s[28:31], s51 offen lds
    buffer_load_dwordx4 v185, s[28:31], s51 offen offset:1024 lds
    buffer_load_dwordx4 v186, s[28:31], s51 offen offset:2048 lds
    buffer_load_dwordx4 v187, s[28:31], s51 offen offset:3072 lds
    s_add_u32 m0, s58, 4096
    s_add_u32 s51, s100, 28672
    buffer_load_dwordx4 v184, s[28:31], s51 offen lds
    buffer_load_dwordx4 v185, s[28:31], s51 offen offset:1024 lds
    buffer_load_dwordx4 v186, s[28:31], s51 offen offset:2048 lds
    buffer_load_dwordx4 v187, s[28:31], s51 offen offset:3072 lds
    s_lshl_b32 s50, s55, 6
    v_bfe_u32 v3, v1, 2, 2
    v_lshrrev_b32 v5, 5, v1
    v_lshl_add_u32 v5, v5, 2, v3
    v_mul_u32_u24 v12, 128, v5
    v_lshrrev_b32 v3, 1, v3
    v_lshl_add_u32 v12, v3, 6, v12
    v_bfe_u32 v3, v1, 4, 1
    v_lshl_add_u32 v12, v3, 5, v12
    v_and_b32 v3, 1, v1
    v_lshl_add_u32 v12, v3, 4, v12
    v_bfe_u32 v3, v1, 1, 1
    v_lshl_add_u32 v12, v3, 3, v12
    s_mul_i32 s48, s55, 28672
    v_add_u32 v12, s48, v12
    v_xor_b32 v12, s50, v12
    v_xor_b32 v13, 64, v12
    v_and_b32 v14, 7, v1
    v_lshlrev_b32 v14, 7, v14
    s_lshr_b32 s48, s47, 1
    s_lshl_b32 s48, s48, 11
    s_and_b32 s50, s47, 1
    s_lshl_b32 s50, s50, 7
    s_add_u32 s48, s48, s50
    s_add_u32 s48, s48, 18876160
    v_and_b32 v3, 1, v1
    v_mul_u32_u24 v250, 14336, v3
    v_lshlrev_b32 v96, 16, v140
    v_and_b32 v97, 0xffff0000, v140
    v_lshlrev_b32 v98, 16, v141
    v_and_b32 v99, 0xffff0000, v141
    v_lshlrev_b32 v100, 16, v142
    v_and_b32 v101, 0xffff0000, v142
    v_lshlrev_b32 v102, 16, v143
    v_and_b32 v103, 0xffff0000, v143
    v_lshlrev_b32 v104, 16, v144
    v_and_b32 v105, 0xffff0000, v144
    v_lshlrev_b32 v106, 16, v145
    v_and_b32 v107, 0xffff0000, v145
    v_lshlrev_b32 v108, 16, v146
    v_and_b32 v109, 0xffff0000, v146
    v_lshlrev_b32 v110, 16, v147
    v_and_b32 v111, 0xffff0000, v147
    s_waitcnt vmcnt(8)
    s_mov_b64 exec, 1
    buffer_store_dword v254, v10, s[40:43], s49 offen sc1
    s_mov_b64 exec, -1
    buffer_load_dword v215, v250, s[40:43], s48 offen sc1
    s_waitcnt vmcnt(0)
    v_cmp_ne_u32 vcc, s101, v215
    s_nop 0
    s_cbranch_vccz L_pollUok_4
    s_mov_b32 s54, 0x40000
L_pollU_5:
    buffer_load_dword v215, v250, s[40:43], s48 offen sc1
    s_sub_u32 s54, s54, 1
    s_waitcnt vmcnt(0)
    s_cbranch_scc1 L_pollU_5_x
    v_cmp_ne_u32 vcc, s101, v215
    s_nop 0
    s_cbranch_vccnz L_pollU_5
L_pollU_5_x:
L_pollUok_4:
    s_lshl_b32 s48, s47, 11
    s_add_u32 s48, s48, 10616832
    s_add_u32 s49, s48, 28672
    buffer_load_dwordx4 v[164:167], v2, s[40:43], s48 offen sc1
    buffer_load_dwordx4 v[168:171], v2, s[40:43], s48 offen offset:1024 sc1
    buffer_load_dwordx4 v[172:175], v2, s[40:43], s49 offen sc1
    buffer_load_dwordx4 v[176:179], v2, s[40:43], s49 offen offset:1024 sc1
    s_lshl_b32 s48, s62, 11
    s_lshl_b32 s49, s55, 10
    s_add_u32 s48, s48, s49
    s_add_u32 s48, s48, 18350080
    s_add_u32 s49, s58, 8192
    v_add_u32 v3, s49, v2
    v_add_u32 v4, 122880, v192
    s_lshl_b32 s50, s62, 15
    s_lshl_b32 s49, s55, 14
    s_add_u32 s50, s50, s49
    s_add_u32 s50, s50, 6291456
    ds_read_b64_tr_b16 v[20:21], v13 offset:0
    ds_read_b64_tr_b16 v[22:23], v13 offset:1024
    ds_read_b64_tr_b16 v[16:17], v12 offset:0
    ds_read_b64_tr_b16 v[18:19], v12 offset:1024
    ds_read_b64_tr_b16 v[28:29], v13 offset:2048
    ds_read_b64_tr_b16 v[30:31], v13 offset:3072
    ds_read_b64_tr_b16 v[24:25], v12 offset:2048
    ds_read_b64_tr_b16 v[26:27], v12 offset:3072
    s_mov_b32 s54, 0x40000
    s_mov_b32 vcc_lo, s101
    s_mov_b32 vcc_hi, s101
L_pollB_6:
    s_buffer_load_dword s8, s[40:43], s48 offset:0 glc
    s_buffer_load_dword s9, s[40:43], s48 offset:128 glc
    s_buffer_load_dword s10, s[40:43], s48 offset:256 glc
    s_buffer_load_dword s11, s[40:43], s48 offset:384 glc
    s_buffer_load_dword s32, s[40:43], s48 offset:512 glc
    s_buffer_load_dword s33, s[40:43], s48 offset:640 glc
    s_buffer_load_dword s34, s[40:43], s48 offset:768 glc
    s_buffer_load_dword s35, s[40:43], s48 offset:896 glc
    s_sub_u32 s54, s54, 1
    s_waitcnt lgkmcnt(0)
    s_cbranch_scc1 L_pollB_6_x
    s_xor_b64 s[8:9], s[8:9], vcc
    s_xor_b64 s[10:11], s[10:11], vcc
    s_xor_b64 s[32:33], s[32:33], vcc
    s_xor_b64 s[34:35], s[34:35], vcc
    s_or_b64 s[8:9], s[8:9], s[10:11]
    s_or_b64 s[8:9], s[8:9], s[32:33]
    s_or_b64 s[8:9], s[8:9], s[34:35]
    s_cbranch_scc1 L_pollB_6
L_pollB_6_x:
    buffer_load_dwordx4 a[0:3], v2, s[40:43], s50 offen offset:0 sc1
    buffer_load_dwordx4 a[4:7], v2, s[40:43], s50 offen offset:1024 sc1
    buffer_load_dwordx4 a[8:11], v2, s[40:43], s50 offen offset:2048 sc1
    buffer_load_dwordx4 a[12:15], v2, s[40:43], s50 offen offset:3072 sc1
    s_add_u32 s50, s50, 4096
    buffer_load_dwordx4 a[16:19], v2, s[40:43], s50 offen offset:0 sc1
    buffer_load_dwordx4 a[20:23], v2, s[40:43], s50 offen offset:1024 sc1
    buffer_load_dwordx4 a[24:27], v2, s[40:43], s50 offen offset:2048 sc1
    buffer_load_dwordx4 a[28:31], v2, s[40:43], s50 offen offset:3072 sc1
    s_add_u32 s50, s50, 4096
    s_waitcnt vmcnt(7)
    v_mfma_f32_32x32x16_bf16 v[112:127], v[20:23], a[0:3], 0
    buffer_load_dwordx4 a[32:35], v2, s[40:43], s50 offen offset:0 sc1
    ds_read_b64_tr_b16 v[36:37], v13 offset:3584
    v_mfma_f32_32x32x16_bf16 v[96:111], v[16:19], a[0:3], v[96:111]
    ds_read_b64_tr_b16 v[38:39], v13 offset:4608
    ds_read_b64_tr_b16 v[32:33], v12 offset:3584
    ds_read_b64_tr_b16 v[34:35], v12 offset:4608
    s_waitcnt vmcnt(7)
    v_mfma_f32_32x32x16_bf16 v[112:127], v[28:31], a[4:7], v[112:127]
    buffer_load_dwordx4 a[36:39], v2, s[40:43], s50 offen offset:1024 sc1
    ds_read_b64_tr_b16 v[20:21], v13 offset:5632
    v_mfma_f32_32x32x16_bf16 v[96:111], v[24:27], a[4:7], v[96:111]
    ds_read_b64_tr_b16 v[22:23], v13 offset:6656
    ds_read_b64_tr_b16 v[16:17], v12 offset:5632
    ds_read_b64_tr_b16 v[18:19], v12 offset:6656
    s_waitcnt vmcnt(7) lgkmcnt(6)
    v_mfma_f32_32x32x16_bf16 v[112:127], v[36:39], a[8:11], v[112:127]
    buffer_load_dwordx4 a[40:43], v2, s[40:43], s50 offen offset:2048 sc1
    ds_read_b64_tr_b16 v[28:29], v13 offset:7168
    s_waitcnt lgkmcnt(5)
    v_mfma_f32_32x32x16_bf16 v[96:111], v[32:35], a[8:11], v[96:111]
    ds_read_b64_tr_b16 v[30:31], v13 offset:8192
    ds_read_b64_tr_b16 v[24:25], v12 offset:7168
    ds_read_b64_tr_b16 v[26:27], v12 offset:8192
    s_waitcnt vmcnt(7) lgkmcnt(6)
    v_mfma_f32_32x32x16_bf16 v[112:127], v[20:23], a[12:15], v[112:127]
    buffer_load_dwordx4 a[44:47], v2, s[40:43], s50 offen offset:3072 sc1
    s_add_u32 s50, s50, 4096
    ds_read_b64_tr_b16 v[36:37], v13 offset:9216
    s_waitcnt lgkmcnt(5)
    v_mfma_f32_32x32x16_bf16 v[96:111], v[16:19], a[12:15], v[96:111]
    ds_read_b64_tr_b16 v[38:39], v13 offset:10240
    ds_read_b64_tr_b16 v[32:33], v12 offset:9216
    ds_read_b64_tr_b16 v[34:35], v12 offset:10240
    s_waitcnt vmcnt(7) lgkmcnt(6)
    v_mfma_f32_32x32x16_bf16 v[112:127], v[28:31], a[16:19], v[112:127]
    buffer_load_dwordx4 a[48:51], v2, s[40:43], s50 offen offset:0 sc1
    ds_read_b64_tr_b16 v[20:21], v13 offset:10752
    s_waitcnt lgkmcnt(5)
    v_mfma_f32_32x32x16_bf16 v[96:111], v[24:27], a[16:19], v[96:111]
    ds_read_b64_tr_b16 v[22:23], v13 offset:11776
    ds_read_b64_tr_b16 v[16:17], v12 offset:10752
    ds_read_b64_tr_b16 v[18:19], v12 offset:11776
    s_waitcnt vmcnt(7) lgkmcnt(6)
    v_mfma_f32_32x32x16_bf16 v[112:127], v[36:39], a[20:23], v[112:127]
    buffer_load_dwordx4 a[52:55], v2, s[40:43], s50 offen offset:1024 sc1
    ds_read_b64_tr_b16 v[28:29], v13 offset:12800
    s_waitcnt lgkmcnt(5)
    v_mfma_f32_32x32x16_bf16 v[96:111], v[32:35], a[20:23], v[96:111]
    ds_read_b64_tr_b16 v[30:31], v13 offset:13824
    ds_read_b64_tr_b16 v[24:25], v12 offset:12800
    ds_read_b64_tr_b16 v[26:27], v12 offset:13824
    s_waitcnt vmcnt(7) lgkmcnt(6)
    v_mfma_f32_32x32x16_bf16 v[112:127], v[20:23], a[24:27], v[112:127]
    buffer_load_dwordx4 a[56:59], v2, s[40:43], s50 offen offset:2048 sc1
    ds_read_b64_tr_b16 v[36:37], v13 offset:14336
    s_waitcnt lgkmcnt(5)
    v_mfma_f32_32x32x16_bf16 v[96:111], v[16:19], a[24:27], v[96:111]
    ds_read_b64_tr_b16 v[38:39], v13 offset:15360
    ds_read_b64_tr_b16 v[32:33], v12 offset:14336
    ds_read_b64_tr_b16 v[34:35], v12 offset:15360
    s_waitcnt vmcnt(7) lgkmcnt(6)
    v_mfma_f32_32x32x16_bf16 v[112:127], v[28:31], a[28:31], v[112:127]
    buffer_load_dwordx4 a[60:63], v2, s[40:43], s50 offen offset:3072 sc1
    s_add_u32 s50, s50, 4096
    ds_read_b64_tr_b16 v[20:21], v13 offset:16384
    s_waitcnt lgkmcnt(5)
    v_mfma_f32_32x32x16_bf16 v[96:111], v[24:27], a[28:31], v[96:111]
    ds_read_b64_tr_b16 v[22:23], v13 offset:17408
    ds_read_b64_tr_b16 v[16:17], v12 offset:16384
    ds_read_b64_tr_b16 v[18:19], v12 offset:17408
    s_waitcnt vmcnt(7) lgkmcnt(6)
    v_mfma_f32_32x32x16_bf16 v[112:127], v[36:39], a[32:35], v[112:127]
    ds_read_b64_tr_b16 v[28:29], v13 offset:17920
    ds_read_b64_tr_b16 v[30:31], v13 offset:18944
    s_waitcnt lgkmcnt(6)
    v_mfma_f32_32x32x16_bf16 v[96:111], v[32:35], a[32:35], v[96:111]
    ds_read_b64_tr_b16 v[24:25], v12 offset:17920
    ds_read_b64_tr_b16 v[26:27], v12 offset:18944
    s_waitcnt vmcnt(6) lgkmcnt(6)
    v_mfma_f32_32x32x16_bf16 v[112:127], v[20:23], a[36:39], v[112:127]
    ds_read_b64_tr_b16 v[36:37], v13 offset:19968
    ds_read_b64_tr_b16 v[38:39], v13 offset:20992
    s_waitcnt lgkmcnt(6)
    v_mfma_f32_32x32x16_bf16 v[96:111], v[16:19], a[36:39], v[96:111]
    ds_read_b64_tr_b16 v[32:33], v12 offset:19968
    ds_read_b64_tr_b16 v[34:35], v12 offset:20992
    s_waitcnt vmcnt(5) lgkmcnt(6)
    v_mfma_f32_32x32x16_bf16 v[112:127], v[28:31], a[40:43], v[112:127]
    ds_read_b64_tr_b16 v[20:21], v13 offset:21504
    ds_read_b64_tr_b16 v[22:23], v13 offset:22528
    s_waitcnt lgkmcnt(6)
    v_mfma_f32_32x32x16_bf16 v[96:111], v[24:27], a[40:43], v[96:111]
    ds_read_b64_tr_b16 v[16:17], v12 offset:21504
    ds_read_b64_tr_b16 v[18:19], v12 offset:22528
    s_waitcnt vmcnt(4) lgkmcnt(6)
    v_mfma_f32_32x32x16_bf16 v[112:127], v[36:39], a[44:47], v[112:127]
    ds_read_b64_tr_b16 v[28:29], v13 offset:23552
    ds_read_b64_tr_b16 v[30:31], v13 offset:24576
    s_waitcnt lgkmcnt(6)
    v_mfma_f32_32x32x16_bf16 v[96:111], v[32:35], a[44:47], v[96:111]
    ds_read_b64_tr_b16 v[24:25], v12 offset:23552
    ds_read_b64_tr_b16 v[26:27], v12 offset:24576
    s_waitcnt vmcnt(3) lgkmcnt(6)
    v_mfma_f32_32x32x16_bf16 v[112:127], v[20:23], a[48:51], v[112:127]
    ds_read_b64_tr_b16 v[36:37], v13 offset:25088
    ds_read_b64_tr_b16 v[38:39], v13 offset:26112
    s_waitcnt lgkmcnt(6)
    v_mfma_f32_32x32x16_bf16 v[96:111], v[16:19], a[48:51], v[96:111]
    ds_read_b64_tr_b16 v[32:33], v12 offset:25088
    ds_read_b64_tr_b16 v[34:35], v12 offset:26112
    s_waitcnt vmcnt(2) lgkmcnt(6)
    v_mfma_f32_32x32x16_bf16 v[112:127], v[28:31], a[52:55], v[112:127]
    ds_read_b64_tr_b16 v[20:21], v13 offset:27136
    ds_read_b64_tr_b16 v[22:23], v13 offset:28160
    s_waitcnt lgkmcnt(6)
    v_mfma_f32_32x32x16_bf16 v[96:111], v[24:27], a[52:55], v[96:111]
    ds_read_b64_tr_b16 v[16:17], v12 offset:27136
    ds_read_b64_tr_b16 v[18:19], v12 offset:28160
    s_waitcnt vmcnt(1) lgkmcnt(6)
    v_mfma_f32_32x32x16_bf16 v[112:127], v[36:39], a[56:59], v[112:127]
    s_mul_i32 s48, s62, 28672
    s_lshl_b32 s49, s63, 11
    s_add_u32 s48, s48, s49
    s_add_u32 s48, s48, 8388608
    s_waitcnt vmcnt(0) lgkmcnt(2)
    v_mfma_f32_32x32x16_bf16 v[112:127], v[20:23], a[60:63], v[112:127]
    s_mul_i32 s50, s62, 3584
    s_lshl_b32 s49, s63, 8
    s_add_u32 s50, s50, s49
    s_add_u32 s50, s50, 10354688
    v_mfma_f32_32x32x16_bf16 v[96:111], v[32:35], a[56:59], v[96:111]
    s_lshl_b32 s52, s62, 4
    s_add_u32 s52, s52, s63
    s_lshl_b32 s52, s52, 7
    s_waitcnt lgkmcnt(0)
    v_mfma_f32_32x32x16_bf16 v[96:111], v[16:19], a[60:63], v[96:111]
    s_add_u32 s52, s52, 18481152
    v_mov_b32 v40, 0
    v_mov_b32 v41, 0
    v_lshlrev_b32 v5, 3, v1
    ds_write_b128 v3, v[112:115] offset:0
    ds_write_b128 v3, v[116:119] offset:1024
    ds_write_b128 v3, v[120:123] offset:2048
    ds_write_b128 v3, v[124:127] offset:3072
    s_waitcnt lgkmcnt(0)
    s_barrier
    ds_read_b128 v[44:47], v4 offset:0
    ds_read_b128 v[48:51], v4 offset:1024
    ds_read_b128 v[52:55], v4 offset:2048
    ds_read_b128 v[56:59], v4 offset:3072
    s_waitcnt lgkmcnt(3)
    v_pk_add_f32 v[96:97], v[96:97], v[44:45]
    v_pk_add_f32 v[98:99], v[98:99], v[46:47]
    s_waitcnt lgkmcnt(2)
    v_pk_add_f32 v[100:101], v[100:101], v[48:49]
    v_pk_add_f32 v[102:103], v[102:103], v[50:51]
    v_cvt_pk_bf16_f32 v148, v96, v97
    v_cvt_pk_bf16_f32 v149, v98, v99
    v_cvt_pk_bf16_f32 v150, v100, v101
    v_cvt_pk_bf16_f32 v151, v102, v103
    buffer_store_dwordx4 v[148:151], v2, s[40:43], s48 offen offset:0 sc1
    s_waitcnt lgkmcnt(1)
    v_pk_add_f32 v[104:105], v[104:105], v[52:53]
    v_pk_add_f32 v[106:107], v[106:107], v[54:55]
    s_waitcnt lgkmcnt(0)
    v_pk_add_f32 v[108:109], v[108:109], v[56:57]
    v_pk_add_f32 v[110:111], v[110:111], v[58:59]
    v_cvt_pk_bf16_f32 v152, v104, v105
    v_cvt_pk_bf16_f32 v153, v106, v107
    v_cvt_pk_bf16_f32 v154, v108, v109
    v_cvt_pk_bf16_f32 v155, v110, v111
    buffer_store_dwordx4 v[152:155], v2, s[40:43], s48 offen offset:1024 sc1
    v_dot2c_f32_bf16 v40, s45, v148
    v_dot2c_f32_bf16 v41, v148, v148
    v_dot2c_f32_bf16 v40, s45, v149
    v_dot2c_f32_bf16 v41, v149, v149
    v_dot2c_f32_bf16 v40, s45, v150
    v_dot2c_f32_bf16 v41, v150, v150
    v_dot2c_f32_bf16 v40, s45, v151
    v_dot2c_f32_bf16 v41, v151, v151
    v_dot2c_f32_bf16 v40, s45, v152
    v_dot2c_f32_bf16 v41, v152, v152
    v_dot2c_f32_bf16 v40, s45, v153
    v_dot2c_f32_bf16 v41, v153, v153
    v_dot2c_f32_bf16 v40, s45, v154
    v_dot2c_f32_bf16 v41, v154, v154
    v_dot2c_f32_bf16 v40, s45, v155
    v_dot2c_f32_bf16 v41, v155, v155
    s_nop 1
    v_mov_b32 v42, v40
    v_mov_b32 v43, v41
    s_nop 0
    v_permlane32_swap_b32 v42, v40
    v_permlane32_swap_b32 v43, v41
    v_pk_add_f32 v[40:41], v[40:41], v[42:43]
    s_mov_b32 exec_hi, 0
    buffer_store_dwordx2 v[40:41], v5, s[40:43], s50 offen sc1
    s_mov_b64 exec, -1
    s_lshl_b32 s53, s46, 2
    s_add_u32 s53, s53, s44
    v_and_b32 v242, 3, v1
    v_bfe_u32 v3, v1, 2, 1
    v_lshl_add_u32 v242, v3, 4, v242
    v_lshlrev_b32 v242, 7, v242
    s_mul_i32 s12, s44, 7
    s_lshr_b32 s12, s12, 1
    s_lshl_b32 s48, s61, 4
    s_add_u32 s12, s12, s48
    s_lshl_b32 s12, s12, 7
    s_add_u32 s12, s12, 18612224
    s_mul_i32 s98, s61, 114688
    s_add_u32 s98, s98, s59
    s_add_u32 s98, s98, 10747904
    s_lshr_b32 s48, s44, 1
    s_mul_i32 s49, s48, 114688
    v_add_u32 v240, s49, v2
    s_sub_u32 s49, 114688, s49
    v_add_u32 v241, s49, v2
    s_mul_i32 s14, s53, 114688
    s_lshl_b32 s49, s47, 12
    s_add_u32 s14, s14, s49
    s_add_u32 s14, s14, 10747904
    s_add_u32 s15, s14, 57344
    s_lshl_b32 s13, s53, 4
    s_add_u32 s13, s13, s47
    s_lshl_b32 s13, s13, 7
    s_add_u32 s13, s13, 18612224
    s_lshl_b32 s48, s53, 11
    s_add_u32 s48, s48, 18481152
    s_mul_i32 s50, s53, 28672
    s_add_u32 s50, s50, 8388608
    s_mul_i32 s49, s53, 3584
    s_add_u32 s49, s49, 10354688
    v_mov_b32 v182, 0
    v_mov_b32 v183, 0
    v_lshlrev_b32 v112, 16, v148
    v_lshlrev_b32 v6, 16, v156
    v_and_b32 v113, 0xffff0000, v148
    v_and_b32 v7, 0xffff0000, v156
    v_pk_add_f32 v[112:113], v[112:113], v[6:7]
    v_lshlrev_b32 v114, 16, v149
    v_lshlrev_b32 v6, 16, v157
    v_and_b32 v115, 0xffff0000, v149
    v_and_b32 v7, 0xffff0000, v157
    v_pk_add_f32 v[114:115], v[114:115], v[6:7]
    v_lshlrev_b32 v116, 16, v150
    v_lshlrev_b32 v6, 16, v158
    v_and_b32 v117, 0xffff0000, v150
    v_and_b32 v7, 0xffff0000, v158
    v_pk_add_f32 v[116:117], v[116:117], v[6:7]
    v_lshlrev_b32 v118, 16, v151
    v_lshlrev_b32 v6, 16, v159
    v_and_b32 v119, 0xffff0000, v151
    v_and_b32 v7, 0xffff0000, v159
    v_pk_add_f32 v[118:119], v[118:119], v[6:7]
    v_lshlrev_b32 v120, 16, v152
    v_lshlrev_b32 v6, 16, v160
    v_and_b32 v121, 0xffff0000, v152
    v_and_b32 v7, 0xffff0000, v160
    v_pk_add_f32 v[120:121], v[120:121], v[6:7]
    v_lshlrev_b32 v122, 16, v153
    v_lshlrev_b32 v6, 16, v161
    v_and_b32 v123, 0xffff0000, v153
    v_and_b32 v7, 0xffff0000, v161
    v_pk_add_f32 v[122:123], v[122:123], v[6:7]
    v_lshlrev_b32 v124, 16, v154
    v_lshlrev_b32 v6, 16, v162
    v_and_b32 v125, 0xffff0000, v154
    v_and_b32 v7, 0xffff0000, v162
    v_pk_add_f32 v[124:125], v[124:125], v[6:7]
    v_lshlrev_b32 v126, 16, v155
    v_lshlrev_b32 v6, 16, v163
    v_and_b32 v127, 0xffff0000, v155
    v_and_b32 v7, 0xffff0000, v163
    v_pk_add_f32 v[126:127], v[126:127], v[6:7]
    s_waitcnt vmcnt(0)
    s_mov_b64 exec, 1
    buffer_store_dword v254, v10, s[24:27], s52 offen
    buffer_store_dword v254, v10, s[4:7], s52 offen sc1
    s_mov_b64 exec, -1
    ds_read_b64_tr_b16 v[12:13], v222 offset:0
    ds_read_b64_tr_b16 v[14:15], v222 offset:512
    ds_read_b64_tr_b16 v[16:17], v223 offset:0
    ds_read_b64_tr_b16 v[18:19], v223 offset:512
    ds_read_b64_tr_b16 v[20:21], v222 offset:2048
    ds_read_b64_tr_b16 v[22:23], v222 offset:2560
    ds_read_b64_tr_b16 v[24:25], v223 offset:2048
    ds_read_b64_tr_b16 v[26:27], v223 offset:2560
    ds_read_b64_tr_b16 v[28:29], v222 offset:4096
    ds_read_b64_tr_b16 v[30:31], v222 offset:4608
    ds_read_b64_tr_b16 v[32:33], v223 offset:4096
    ds_read_b64_tr_b16 v[34:35], v223 offset:4608
    s_mov_b32 s54, 0x40000
L_pollC_7:
    buffer_load_dword v215, v214, s[40:43], s48 offen sc1
    s_sub_u32 s54, s54, 1
    s_waitcnt vmcnt(0)
    s_cbranch_scc1 L_pollC_7_x
    v_cmp_ne_u32 vcc, s101, v215
    s_nop 0
    s_cbranch_vccnz L_pollC_7
L_pollC_7_x:
    buffer_load_dwordx4 a[0:3], v2, s[40:43], s50 offen offset:0 sc1
    buffer_load_dwordx4 a[4:7], v2, s[40:43], s50 offen offset:1024 sc1
    buffer_load_dwordx4 a[8:11], v2, s[40:43], s50 offen offset:2048 sc1
    buffer_load_dwordx4 a[12:15], v2, s[40:43], s50 offen offset:3072 sc1
    s_add_u32 s50, s50, 4096
    buffer_load_dwordx4 a[16:19], v2, s[40:43], s50 offen offset:0 sc1
    buffer_load_dwordx4 a[20:23], v2, s[40:43], s50 offen offset:1024 sc1
    buffer_load_dwordx4 a[24:27], v2, s[40:43], s50 offen offset:2048 sc1
    buffer_load_dwordx4 a[28:31], v2, s[40:43], s50 offen offset:3072 sc1
    s_add_u32 s50, s50, 4096
    s_waitcnt vmcnt(7) lgkmcnt(10)
    v_mfma_f32_32x32x16_bf16 v[48:63], v[12:15], a[0:3], 0
    buffer_load_dwordx4 a[32:35], v2, s[40:43], s50 offen offset:0 sc1
    ds_read_b64_tr_b16 v[36:37], v222 offset:6144
    s_waitcnt lgkmcnt(9)
    v_mfma_f32_32x32x16_bf16 v[64:79], v[16:19], a[0:3], 0
    ds_read_b64_tr_b16 v[38:39], v222 offset:6656
    ds_read_b64_tr_b16 v[40:41], v223 offset:6144
    ds_read_b64_tr_b16 v[42:43], v223 offset:6656
    s_waitcnt vmcnt(7) lgkmcnt(10)
    v_mfma_f32_32x32x16_bf16 v[48:63], v[20:23], a[4:7], v[48:63]
    buffer_load_dwordx4 a[36:39], v2, s[40:43], s50 offen offset:1024 sc1
    ds_read_b64_tr_b16 v[12:13], v222 offset:8192
    s_waitcnt lgkmcnt(9)
    v_mfma_f32_32x32x16_bf16 v[64:79], v[24:27], a[4:7], v[64:79]
    ds_read_b64_tr_b16 v[14:15], v222 offset:8704
    ds_read_b64_tr_b16 v[16:17], v223 offset:8192
    ds_read_b64_tr_b16 v[18:19], v223 offset:8704
    s_waitcnt vmcnt(7) lgkmcnt(10)
    v_mfma_f32_32x32x16_bf16 v[48:63], v[28:31], a[8:11], v[48:63]
    buffer_load_dwordx4 a[40:43], v2, s[40:43], s50 offen offset:2048 sc1
    ds_read_b64_tr_b16 v[20:21], v222 offset:10240
    s_waitcnt lgkmcnt(9)
    v_mfma_f32_32x32x16_bf16 v[64:79], v[32:35], a[8:11], v[64:79]
    ds_read_b64_tr_b16 v[22:23], v222 offset:10752
    ds_read_b64_tr_b16 v[24:25], v223 offset:10240
    ds_read_b64_tr_b16 v[26:27], v223 offset:10752
    s_waitcnt vmcnt(7) lgkmcnt(10)
    v_mfma_f32_32x32x16_bf16 v[48:63], v[36:39], a[12:15], v[48:63]
    buffer_load_dwordx4 a[44:47], v2, s[40:43], s50 offen offset:3072 sc1
    s_add_u32 s50, s50, 4096
    ds_read_b64_tr_b16 v[28:29], v222 offset:12288
    s_waitcnt lgkmcnt(9)
    v_mfma_f32_32x32x16_bf16 v[64:79], v[40:43], a[12:15], v[64:79]
    ds_read_b64_tr_b16 v[30:31], v222 offset:12800
    ds_read_b64_tr_b16 v[32:33], v223 offset:12288
    ds_read_b64_tr_b16 v[34:35], v223 offset:12800
    s_waitcnt vmcnt(7) lgkmcnt(10)
    v_mfma_f32_32x32x16_bf16 v[48:63], v[12:15], a[16:19], v[48:63]
    buffer_load_dwordx4 a[48:51], v2, s[40:43], s50 offen offset:0 sc1
    buffer_load_dwordx2 v[196:197], v5, s[40:43], s49 offen offset:0 sc1
    s_waitcnt lgkmcnt(8)
    v_mfma_f32_32x32x16_bf16 v[64:79], v[16:19], a[16:19], v[64:79]
    ds_read_b64_tr_b16 v[36:37], v222 offset:14336
    ds_read_b64_tr_b16 v[38:39], v222 offset:14848
    ds_read_b64_tr_b16 v[40:41], v223 offset:14336
    ds_read_b64_tr_b16 v[42:43], v223 offset:14848
    s_waitcnt vmcnt(8) lgkmcnt(10)
    v_mfma_f32_32x32x16_bf16 v[48:63], v[20:23], a[20:23], v[48:63]
    buffer_load_dwordx4 a[52:55], v2, s[40:43], s50 offen offset:1024 sc1
    buffer_load_dwordx2 v[198:199], v5, s[40:43], s49 offen offset:512 sc1
    s_waitcnt lgkmcnt(8)
    v_mfma_f32_32x32x16_bf16 v[64:79], v[24:27], a[20:23], v[64:79]
    ds_read_b64_tr_b16 v[12:13], v222 offset:16384
    ds_read_b64_tr_b16 v[14:15], v222 offset:16896
    ds_read_b64_tr_b16 v[16:17], v223 offset:16384
    ds_read_b64_tr_b16 v[18:19], v223 offset:16896
    s_waitcnt vmcnt(9) lgkmcnt(10)
    v_mfma_f32_32x32x16_bf16 v[48:63], v[28:31], a[24:27], v[48:63]
    buffer_load_dwordx4 a[56:59], v2, s[40:43], s50 offen offset:2048 sc1
    buffer_load_dwordx2 v[200:201], v5, s[40:43], s49 offen offset:1024 sc1
    s_waitcnt lgkmcnt(8)
    v_mfma_f32_32x32x16_bf16 v[64:79], v[32:35], a[24:27], v[64:79]
    ds_read_b64_tr_b16 v[20:21], v222 offset:18432
    ds_read_b64_tr_b16 v[22:23], v222 offset:18944
    ds_read_b64_tr_b16 v[24:25], v223 offset:18432
    ds_read_b64_tr_b16 v[26:27], v223 offset:18944
    s_waitcnt vmcnt(10) lgkmcnt(10)
    v_mfma_f32_32x32x16_bf16 v[48:63], v[36:39], a[28:31], v[48:63]
    buffer_load_dwordx4 a[60:63], v2, s[40:43], s50 offen offset:3072 sc1
    s_add_u32 s50, s50, 4096
    buffer_load_dwordx2 v[202:203], v5, s[40:43], s49 offen offset:1536 sc1
    s_waitcnt lgkmcnt(8)
    v_mfma_f32_32x32x16_bf16 v[64:79], v[40:43], a[28:31], v[64:79]
    ds_read_b64_tr_b16 v[28:29], v222 offset:20480
    ds_read_b64_tr_b16 v[30:31], v222 offset:20992
    ds_read_b64_tr_b16 v[32:33], v223 offset:20480
    ds_read_b64_tr_b16 v[34:35], v223 offset:20992
    s_waitcnt vmcnt(11) lgkmcnt(10)
    v_mfma_f32_32x32x16_bf16 v[48:63], v[12:15], a[32:35], v[48:63]
    buffer_load_dwordx4 a[64:67], v2, s[40:43], s50 offen offset:0 sc1
    buffer_load_dwordx2 v[204:205], v5, s[40:43], s49 offen offset:2048 sc1
    s_waitcnt lgkmcnt(8)
    v_mfma_f32_32x32x16_bf16 v[64:79], v[16:19], a[32:35], v[64:79]
    ds_read_b64_tr_b16 v[36:37], v222 offset:22528
    ds_read_b64_tr_b16 v[38:39], v222 offset:23040
    ds_read_b64_tr_b16 v[40:41], v223 offset:22528
    ds_read_b64_tr_b16 v[42:43], v223 offset:23040
    s_waitcnt vmcnt(12) lgkmcnt(10)
    v_mfma_f32_32x32x16_bf16 v[48:63], v[20:23], a[36:39], v[48:63]
    buffer_load_dwordx4 a[68:71], v2, s[40:43], s50 offen offset:1024 sc1
    buffer_load_dwordx2 v[206:207], v5, s[40:43], s49 offen offset:2560 sc1
    s_waitcnt lgkmcnt(8)
    v_mfma_f32_32x32x16_bf16 v[64:79], v[24:27], a[36:39], v[64:79]
    ds_read_b64_tr_b16 v[12:13], v222 offset:24576
    ds_read_b64_tr_b16 v[14:15], v222 offset:25088
    ds_read_b64_tr_b16 v[16:17], v223 offset:24576
    ds_read_b64_tr_b16 v[18:19], v223 offset:25088
    s_waitcnt vmcnt(13) lgkmcnt(10)
    v_mfma_f32_32x32x16_bf16 v[48:63], v[28:31], a[40:43], v[48:63]
    buffer_load_dwordx4 a[72:75], v2, s[40:43], s50 offen offset:2048 sc1
    buffer_load_dwordx2 v[208:209], v5, s[40:43], s49 offen offset:3072 sc1
    s_waitcnt lgkmcnt(8)
    v_mfma_f32_32x32x16_bf16 v[64:79], v[32:35], a[40:43], v[64:79]
    ds_read_b64_tr_b16 v[20:21], v222 offset:26624
    ds_read_b64_tr_b16 v[22:23], v222 offset:27136
    ds_read_b64_tr_b16 v[24:25], v223 offset:26624
    ds_read_b64_tr_b16 v[26:27], v223 offset:27136
    s_waitcnt vmcnt(14) lgkmcnt(10)
    v_mfma_f32_32x32x16_bf16 v[48:63], v[36:39], a[44:47], v[48:63]
    buffer_load_dwordx4 a[76:79], v2, s[40:43], s50 offen offset:3072 sc1
    s_add_u32 s50, s50, 4096
    ds_read_b64_tr_b16 v[28:29], v222 offset:28672
    s_waitcnt lgkmcnt(9)
    v_mfma_f32_32x32x16_bf16 v[64:79], v[40:43], a[44:47], v[64:79]
    ds_read_b64_tr_b16 v[30:31], v222 offset:29184
    ds_read_b64_tr_b16 v[32:33], v223 offset:28672
    ds_read_b64_tr_b16 v[34:35], v223 offset:29184
    s_waitcnt vmcnt(14) lgkmcnt(10)
    v_mfma_f32_32x32x16_bf16 v[48:63], v[12:15], a[48:51], v[48:63]
    buffer_load_dwordx4 a[80:83], v2, s[40:43], s50 offen offset:0 sc1
    ds_read_b64_tr_b16 v[36:37], v222 offset:30720
    s_waitcnt lgkmcnt(9)
    v_mfma_f32_32x32x16_bf16 v[64:79], v[16:19], a[48:51], v[64:79]
    ds_read_b64_tr_b16 v[38:39], v222 offset:31232
    ds_read_b64_tr_b16 v[40:41], v223 offset:30720
    ds_read_b64_tr_b16 v[42:43], v223 offset:31232
    s_waitcnt vmcnt(13) lgkmcnt(10)
    v_mfma_f32_32x32x16_bf16 v[48:63], v[20:23], a[52:55], v[48:63]
    buffer_load_dwordx4 a[84:87], v2, s[40:43], s50 offen offset:1024 sc1
    ds_read_b64_tr_b16 v[12:13], v222 offset:32768
    s_waitcnt lgkmcnt(9)
    v_mfma_f32_32x32x16_bf16 v[64:79], v[24:27], a[52:55], v[64:79]
    ds_read_b64_tr_b16 v[14:15], v222 offset:33280
    ds_read_b64_tr_b16 v[16:17], v223 offset:32768
    ds_read_b64_tr_b16 v[18:19], v223 offset:33280
    s_waitcnt vmcnt(12) lgkmcnt(10)
    v_mfma_f32_32x32x16_bf16 v[48:63], v[28:31], a[56:59], v[48:63]
    buffer_load_dwordx4 a[88:91], v2, s[40:43], s50 offen offset:2048 sc1
    ds_read_b64_tr_b16 v[20:21], v222 offset:34816
    s_waitcnt lgkmcnt(9)
    v_mfma_f32_32x32x16_bf16 v[64:79], v[32:35], a[56:59], v[64:79]
    ds_read_b64_tr_b16 v[22:23], v222 offset:35328
    ds_read_b64_tr_b16 v[24:25], v223 offset:34816
    ds_read_b64_tr_b16 v[26:27], v223 offset:35328
    s_waitcnt vmcnt(11) lgkmcnt(10)
    v_mfma_f32_32x32x16_bf16 v[48:63], v[36:39], a[60:63], v[48:63]
    buffer_load_dwordx4 a[92:95], v2, s[40:43], s50 offen offset:3072 sc1
    s_add_u32 s50, s50, 4096
    ds_read_b64_tr_b16 v[28:29], v222 offset:36864
    s_waitcnt lgkmcnt(9)
    v_mfma_f32_32x32x16_bf16 v[64:79], v[40:43], a[60:63], v[64:79]
    ds_read_b64_tr_b16 v[30:31], v222 offset:37376
    ds_read_b64_tr_b16 v[32:33], v223 offset:36864
    ds_read_b64_tr_b16 v[34:35], v223 offset:37376
    s_waitcnt vmcnt(10) lgkmcnt(10)
    v_mfma_f32_32x32x16_bf16 v[48:63], v[12:15], a[64:67], v[48:63]
    buffer_load_dwordx4 a[96:99], v2, s[40:43], s50 offen offset:0 sc1
    ds_read_b64_tr_b16 v[36:37], v222 offset:38912
    s_waitcnt lgkmcnt(9)
    v_mfma_f32_32x32x16_bf16 v[64:79], v[16:19], a[64:67], v[64:79]
    ds_read_b64_tr_b16 v[38:39], v222 offset:39424
    ds_read_b64_tr_b16 v[40:41], v223 offset:38912
    ds_read_b64_tr_b16 v[42:43], v223 offset:39424
    s_waitcnt vmcnt(9) lgkmcnt(10)
    v_mfma_f32_32x32x16_bf16 v[48:63], v[20:23], a[68:71], v[48:63]
    buffer_load_dwordx4 a[100:103], v2, s[40:43], s50 offen offset:1024 sc1
    ds_read_b64_tr_b16 v[12:13], v222 offset:40960
    s_waitcnt lgkmcnt(9)
    v_mfma_f32_32x32x16_bf16 v[64:79], v[24:27], a[68:71], v[64:79]
    ds_read_b64_tr_b16 v[14:15], v222 offset:41472
    ds_read_b64_tr_b16 v[16:17], v223 offset:40960
    ds_read_b64_tr_b16 v[18:19], v223 offset:41472
    s_waitcnt vmcnt(8) lgkmcnt(10)
    v_mfma_f32_32x32x16_bf16 v[48:63], v[28:31], a[72:75], v[48:63]
    buffer_load_dwordx4 a[104:107], v2, s[40:43], s50 offen offset:2048 sc1
    ds_read_b64_tr_b16 v[20:21], v222 offset:43008
    ds_read_b64_tr_b16 v[22:23], v222 offset:43520
    s_waitcnt lgkmcnt(10)
    v_mfma_f32_32x32x16_bf16 v[64:79], v[32:35], a[72:75], v[64:79]
    ds_read_b64_tr_b16 v[24:25], v223 offset:43008
    ds_read_b64_tr_b16 v[26:27], v223 offset:43520
    v_add_f32 v196, v196, v198
    v_add_f32 v197, v197, v199
    v_add_f32 v196, v196, v200
    v_add_f32 v197, v197, v201
    v_add_f32 v196, v196, v202
    s_waitcnt vmcnt(7) lgkmcnt(10)
    v_mfma_f32_32x32x16_bf16 v[48:63], v[36:39], a[76:79], v[48:63]
    buffer_load_dwordx4 a[108:111], v2, s[40:43], s50 offen offset:3072 sc1
    s_add_u32 s50, s50, 4096
    ds_read_b64_tr_b16 v[28:29], v222 offset:45056
    ds_read_b64_tr_b16 v[30:31], v222 offset:45568
    s_waitcnt lgkmcnt(10)
    v_mfma_f32_32x32x16_bf16 v[64:79], v[40:43], a[76:79], v[64:79]
    ds_read_b64_tr_b16 v[32:33], v223 offset:45056
    ds_read_b64_tr_b16 v[34:35], v223 offset:45568
    v_add_f32 v197, v197, v203
    v_add_f32 v196, v196, v204
    v_add_f32 v197, v197, v205
    v_add_f32 v196, v196, v206
    v_add_f32 v197, v197, v207
    s_waitcnt vmcnt(7) lgkmcnt(10)
    v_mfma_f32_32x32x16_bf16 v[48:63], v[12:15], a[80:83], v[48:63]
    s_add_u32 m0, s59, 0
    s_add_u32 s51, s99, 1792
    buffer_load_dwordx4 v188, s[20:23], s51 offen offset:0 lds
    ds_read_b64_tr_b16 v[36:37], v222 offset:47104
    ds_read_b64_tr_b16 v[38:39], v222 offset:47616
    s_waitcnt lgkmcnt(10)
    v_mfma_f32_32x32x16_bf16 v[64:79], v[16:19], a[80:83], v[64:79]
    ds_read_b64_tr_b16 v[40:41], v223 offset:47104
    ds_read_b64_tr_b16 v[42:43], v223 offset:47616
    v_add_f32 v196, v196, v208
    v_add_f32 v197, v197, v209
    v_mov_b32 v3, v196
    s_nop 1
    v_permlane32_swap_b32 v3, v196
    v_add_f32 v196, v196, v3
    s_waitcnt vmcnt(7) lgkmcnt(10)
    v_mfma_f32_32x32x16_bf16 v[48:63], v[20:23], a[84:87], v[48:63]
    buffer_load_dwordx4 v189, s[20:23], s51 offen offset:1024 lds
    ds_read_b64_tr_b16 v[12:13], v222 offset:49152
    ds_read_b64_tr_b16 v[14:15], v222 offset:49664
    s_waitcnt lgkmcnt(10)
    v_mfma_f32_32x32x16_bf16 v[64:79], v[24:27], a[84:87], v[64:79]
    ds_read_b64_tr_b16 v[16:17], v223 offset:49152
    ds_read_b64_tr_b16 v[18:19], v223 offset:49664
    v_mov_b32 v4, v197
    s_nop 1
    v_permlane32_swap_b32 v4, v197
    v_add_f32 v197, v197, v4
    v_mul_f32 v198, 0xbb124925, v196
    v_mul_f32 v199, 0x3b124925, v197
    s_waitcnt vmcnt(7) lgkmcnt(10)
    v_mfma_f32_32x32x16_bf16 v[48:63], v[28:31], a[88:91], v[48:63]
    buffer_load_dwordx4 v190, s[20:23], s51 offen offset:2048 lds
    ds_read_b64_tr_b16 v[20:21], v222 offset:51200
    ds_read_b64_tr_b16 v[22:23], v222 offset:51712
    ds_read_b64_tr_b16 v[24:25], v223 offset:51200
    s_waitcnt lgkmcnt(11)
    v_mfma_f32_32x32x16_bf16 v[64:79], v[32:35], a[88:91], v[64:79]
    ds_read_b64_tr_b16 v[26:27], v223 offset:51712
    v_fma_f32 v199, -v198, v198, v199
    v_max_f32 v199, 0, v199
    v_add_f32 v3, 0x3727c5ac, v199
    v_fmamk_f32 v3, v3, 0x3727c5ac, v199
    v_rsq_f32 v4, v3
    s_waitcnt vmcnt(7) lgkmcnt(10)
    v_mfma_f32_32x32x16_bf16 v[48:63], v[36:39], a[92:95], v[48:63]
    buffer_load_dwordx4 v191, s[20:23], s51 offen offset:3072 lds
    ds_read_b64_tr_b16 v[28:29], v222 offset:53248
    ds_read_b64_tr_b16 v[30:31], v222 offset:53760
    ds_read_b64_tr_b16 v[32:33], v223 offset:53248
    s_waitcnt lgkmcnt(11)
    v_mfma_f32_32x32x16_bf16 v[64:79], v[40:43], a[92:95], v[64:79]
    ds_read_b64_tr_b16 v[34:35], v223 offset:53760
    v_sqrt_f32 v228, v3
    v_mul_f32 v224, 0xc0135761, v4
    v_mul_f32 v226, v4, v4
    v_mul_f32 v226, v226, v4
    v_mul_f32 v226, 0xbdd2d3e8, v226
    s_waitcnt vmcnt(7) lgkmcnt(10)
    v_mfma_f32_32x32x16_bf16 v[48:63], v[12:15], a[96:99], v[48:63]
    s_add_u32 m0, s59, 4096
    s_add_u32 s51, s99, 116480
    buffer_load_dwordx4 v188, s[20:23], s51 offen offset:0 lds
    ds_read_b64_tr_b16 v[36:37], v222 offset:55296
    ds_read_b64_tr_b16 v[38:39], v222 offset:55808
    s_waitcnt lgkmcnt(10)
    v_mfma_f32_32x32x16_bf16 v[64:79], v[16:19], a[96:99], v[64:79]
    ds_read_b64_tr_b16 v[40:41], v223 offset:55296
    ds_read_b64_tr_b16 v[42:43], v223 offset:55808
    v_cmp_lt_u32 vcc, 31, v1
    v_cvt_pk_bf16_f32 v180, v198, v198
    v_and_b32 v4, 0xffff0000, v180
    v_sub_f32 v4, v198, v4
    v_cvt_pk_bf16_f32 v4, v4, v4
    s_waitcnt vmcnt(7) lgkmcnt(10)
    v_mfma_f32_32x32x16_bf16 v[48:63], v[20:23], a[100:103], v[48:63]
    buffer_load_dwordx4 v189, s[20:23], s51 offen offset:1024 lds
    v_cndmask_b32 v180, v180, v4, vcc
    s_waitcnt lgkmcnt(8)
    v_mfma_f32_32x32x16_bf16 v[64:79], v[24:27], a[100:103], v[64:79]
    v_cvt_pk_bf16_f32 v181, v228, v228
    v_and_b32 v4, 0xffff0000, v181
    v_sub_f32 v4, v228, v4
    v_cvt_pk_bf16_f32 v4, v4, v4
    s_waitcnt vmcnt(7) lgkmcnt(6)
    v_mfma_f32_32x32x16_bf16 v[48:63], v[28:31], a[104:107], v[48:63]
    buffer_load_dwordx4 v190, s[20:23], s51 offen offset:2048 lds
    s_waitcnt lgkmcnt(4)
    v_mfma_f32_32x32x16_bf16 v[64:79], v[32:35], a[104:107], v[64:79]
    v_cndmask_b32 v181, v181, v4, vcc
    s_waitcnt vmcnt(7) lgkmcnt(2)
    v_mfma_f32_32x32x16_bf16 v[48:63], v[36:39], a[108:111], v[48:63]
    buffer_load_dwordx4 v191, s[20:23], s51 offen offset:3072 lds
    s_waitcnt lgkmcnt(0)
    v_mfma_f32_32x32x16_bf16 v[64:79], v[40:43], a[108:111], v[64:79]
    v_mfma_f32_32x32x16_bf16 v[48:63], v[164:167], v[180:183], v[48:63]
    v_mfma_f32_32x32x16_bf16 v[64:79], v[168:171], v[180:183], v[64:79]
    s_nop 10
    v_pk_mul_f32 v[232:233], v[48:49], v[48:49]
    v_pk_mul_f32 v[234:235], v[50:51], v[50:51]
    v_pk_mul_f32 v[236:237], v[52:53], v[52:53]
    v_pk_mul_f32 v[238:239], v[54:55], v[54:55]
    v_pk_fma_f32 v[232:233], v[232:233], v[226:227], v[224:225] op_sel_hi:[1,0,0]
    v_pk_fma_f32 v[234:235], v[234:235], v[226:227], v[224:225] op_sel_hi:[1,0,0]
    s_add_u32 m0, s59, 8192
    s_add_u32 s51, s99, 231168
    buffer_load_dwordx4 v188, s[20:23], s51 offen offset:0 lds
    v_pk_fma_f32 v[236:237], v[236:237], v[226:227], v[224:225] op_sel_hi:[1,0,0]
    v_pk_fma_f32 v[238:239], v[238:239], v[226:227], v[224:225] op_sel_hi:[1,0,0]
    v_pk_mul_f32 v[232:233], v[232:233], v[48:49]
    v_pk_mul_f32 v[234:235], v[234:235], v[50:51]
    v_pk_mul_f32 v[236:237], v[236:237], v[52:53]
    v_pk_mul_f32 v[238:239], v[238:239], v[54:55]
    buffer_load_dwordx4 v189, s[20:23], s51 offen offset:1024 lds
    v_exp_f32 v232, v232
    v_exp_f32 v233, v233
    v_exp_f32 v234, v234
    v_exp_f32 v235, v235
    v_exp_f32 v236, v236
    v_exp_f32 v237, v237
    buffer_load_dwordx4 v190, s[20:23], s51 offen offset:2048 lds
    v_exp_f32 v238, v238
    v_exp_f32 v239, v239
    v_pk_fma_f32 v[232:233], v[232:233], v[228:229], v[228:229] op_sel_hi:[1,0,0]
    v_pk_fma_f32 v[234:235], v[234:235], v[228:229], v[228:229] op_sel_hi:[1,0,0]
    v_pk_fma_f32 v[236:237], v[236:237], v[228:229], v[228:229] op_sel_hi:[1,0,0]
    v_pk_fma_f32 v[238:239], v[238:239], v[228:229], v[228:229] op_sel_hi:[1,0,0]
    buffer_load_dwordx4 v191, s[20:23], s51 offen offset:3072 lds
    v_rcp_f32 v232, v232
    v_rcp_f32 v233, v233
    v_rcp_f32 v234, v234
    v_rcp_f32 v235, v235
    v_rcp_f32 v236, v236
    v_rcp_f32 v237, v237
    s_add_u32 m0, s59, 12288
    s_add_u32 s51, s99, 345856
    buffer_load_dwordx4 v188, s[20:23], s51 offen offset:0 lds
    v_rcp_f32 v238, v238
    v_rcp_f32 v239, v239
    v_pk_mul_f32 v[232:233], v[232:233], v[48:49]
    v_pk_mul_f32 v[234:235], v[234:235], v[50:51]
    v_pk_mul_f32 v[236:237], v[236:237], v[52:53]
    v_pk_mul_f32 v[238:239], v[238:239], v[54:55]
    buffer_load_dwordx4 v189, s[20:23], s51 offen offset:1024 lds
    v_cvt_pk_bf16_f32 v48, v232, v233
    v_cvt_pk_bf16_f32 v49, v234, v235
    v_cvt_pk_bf16_f32 v50, v236, v237
    v_cvt_pk_bf16_f32 v51, v238, v239
    buffer_store_dwordx4 v[48:51], v2, s[40:43], s14 offen offset:0 sc1
    v_pk_mul_f32 v[232:233], v[56:57], v[56:57]
    v_pk_mul_f32 v[234:235], v[58:59], v[58:59]
    v_pk_mul_f32 v[236:237], v[60:61], v[60:61]
    v_pk_mul_f32 v[238:239], v[62:63], v[62:63]
    v_pk_fma_f32 v[232:233], v[232:233], v[226:227], v[224:225] op_sel_hi:[1,0,0]
    v_pk_fma_f32 v[234:235], v[234:235], v[226:227], v[224:225] op_sel_hi:[1,0,0]
    v_pk_fma_f32 v[236:237], v[236:237], v[226:227], v[224:225] op_sel_hi:[1,0,0]
    v_pk_fma_f32 v[238:239], v[238:239], v[226:227], v[224:225] op_sel_hi:[1,0,0]
    v_pk_mul_f32 v[232:233], v[232:233], v[56:57]
    v_pk_mul_f32 v[234:235], v[234:235], v[58:59]
    v_pk_mul_f32 v[236:237], v[236:237], v[60:61]
    v_pk_mul_f32 v[238:239], v[238:239], v[62:63]
    v_exp_f32 v232, v232
    v_exp_f32 v233, v233
    v_exp_f32 v234, v234
    v_exp_f32 v235, v235
    v_exp_f32 v236, v236
    v_exp_f32 v237, v237
    v_exp_f32 v238, v238
    v_exp_f32 v239, v239
    v_pk_fma_f32 v[232:233], v[232:233], v[228:229], v[228:229] op_sel_hi:[1,0,0]
    v_pk_fma_f32 v[234:235], v[234:235], v[228:229], v[228:229] op_sel_hi:[1,0,0]
    v_pk_fma_f32 v[236:237], v[236:237], v[228:229], v[228:229] op_sel_hi:[1,0,0]
    v_pk_fma_f32 v[238:239], v[238:239], v[228:229], v[228:229] op_sel_hi:[1,0,0]
    v_rcp_f32 v232, v232
    v_rcp_f32 v233, v233
    v_rcp_f32 v234, v234
    v_rcp_f32 v235, v235
    v_rcp_f32 v236, v236
    v_rcp_f32 v237, v237
    v_rcp_f32 v238, v238
    v_rcp_f32 v239, v239
    v_pk_mul_f32 v[232:233], v[232:233], v[56:57]
    v_pk_mul_f32 v[234:235], v[234:235], v[58:59]
    v_pk_mul_f32 v[236:237], v[236:237], v[60:61]
    v_pk_mul_f32 v[238:239], v[238:239], v[62:63]
    v_cvt_pk_bf16_f32 v56, v232, v233
    v_cvt_pk_bf16_f32 v57, v234, v235
    v_cvt_pk_bf16_f32 v58, v236, v237
    v_cvt_pk_bf16_f32 v59, v238, v239
    buffer_store_dwordx4 v[56:59], v2, s[40:43], s14 offen offset:1024 sc1
    v_pk_mul_f32 v[232:233], v[64:65], v[64:65]
    v_pk_mul_f32 v[234:235], v[66:67], v[66:67]
    v_pk_mul_f32 v[236:237], v[68:69], v[68:69]
    v_pk_mul_f32 v[238:239], v[70:71], v[70:71]
    v_pk_fma_f32 v[232:233], v[232:233], v[226:227], v[224:225] op_sel_hi:[1,0,0]
    v_pk_fma_f32 v[234:235], v[234:235], v[226:227], v[224:225] op_sel_hi:[1,0,0]
    v_pk_fma_f32 v[236:237], v[236:237], v[226:227], v[224:225] op_sel_hi:[1,0,0]
    v_pk_fma_f32 v[238:239], v[238:239], v[226:227], v[224:225] op_sel_hi:[1,0,0]
    v_pk_mul_f32 v[232:233], v[232:233], v[64:65]
    v_pk_mul_f32 v[234:235], v[234:235], v[66:67]
    v_pk_mul_f32 v[236:237], v[236:237], v[68:69]
    v_pk_mul_f32 v[238:239], v[238:239], v[70:71]
    v_exp_f32 v232, v232
    v_exp_f32 v233, v233
    v_exp_f32 v234, v234
    v_exp_f32 v235, v235
    v_exp_f32 v236, v236
    v_exp_f32 v237, v237
    v_exp_f32 v238, v238
    v_exp_f32 v239, v239
    v_pk_fma_f32 v[232:233], v[232:233], v[228:229], v[228:229] op_sel_hi:[1,0,0]
    v_pk_fma_f32 v[234:235], v[234:235], v[228:229], v[228:229] op_sel_hi:[1,0,0]
    v_pk_fma_f32 v[236:237], v[236:237], v[228:229], v[228:229] op_sel_hi:[1,0,0]
    v_pk_fma_f32 v[238:239], v[238:239], v[228:229], v[228:229] op_sel_hi:[1,0,0]
    v_rcp_f32 v232, v232
    v_rcp_f32 v233, v233
    v_rcp_f32 v234, v234
    v_rcp_f32 v235, v235
    v_rcp_f32 v236, v236
    v_rcp_f32 v237, v237
    v_rcp_f32 v238, v238
    v_rcp_f32 v239, v239
    v_pk_mul_f32 v[232:233], v[232:233], v[64:65]
    v_pk_mul_f32 v[234:235], v[234:235], v[66:67]
    v_pk_mul_f32 v[236:237], v[236:237], v[68:69]
    v_pk_mul_f32 v[238:239], v[238:239], v[70:71]
    v_cvt_pk_bf16_f32 v64, v232, v233
    v_cvt_pk_bf16_f32 v65, v234, v235
    v_cvt_pk_bf16_f32 v66, v236, v237
    v_cvt_pk_bf16_f32 v67, v238, v239
    buffer_store_dwordx4 v[64:67], v2, s[40:43], s14 offen offset:2048 sc1
    v_pk_mul_f32 v[232:233], v[72:73], v[72:73]
    v_pk_mul_f32 v[234:235], v[74:75], v[74:75]
    v_pk_mul_f32 v[236:237], v[76:77], v[76:77]
    v_pk_mul_f32 v[238:239], v[78:79], v[78:79]
    v_pk_fma_f32 v[232:233], v[232:233], v[226:227], v[224:225] op_sel_hi:[1,0,0]
    v_pk_fma_f32 v[234:235], v[234:235], v[226:227], v[224:225] op_sel_hi:[1,0,0]
    v_pk_fma_f32 v[236:237], v[236:237], v[226:227], v[224:225] op_sel_hi:[1,0,0]
    v_pk_fma_f32 v[238:239], v[238:239], v[226:227], v[224:225] op_sel_hi:[1,0,0]
    v_pk_mul_f32 v[232:233], v[232:233], v[72:73]
    v_pk_mul_f32 v[234:235], v[234:235], v[74:75]
    v_pk_mul_f32 v[236:237], v[236:237], v[76:77]
    v_pk_mul_f32 v[238:239], v[238:239], v[78:79]
    v_exp_f32 v232, v232
    v_exp_f32 v233, v233
    v_exp_f32 v234, v234
    v_exp_f32 v235, v235
    v_exp_f32 v236, v236
    v_exp_f32 v237, v237
    v_exp_f32 v238, v238
    v_exp_f32 v239, v239
    v_pk_fma_f32 v[232:233], v[232:233], v[228:229], v[228:229] op_sel_hi:[1,0,0]
    v_pk_fma_f32 v[234:235], v[234:235], v[228:229], v[228:229] op_sel_hi:[1,0,0]
    v_pk_fma_f32 v[236:237], v[236:237], v[228:229], v[228:229] op_sel_hi:[1,0,0]
    v_pk_fma_f32 v[238:239], v[238:239], v[228:229], v[228:229] op_sel_hi:[1,0,0]
    v_rcp_f32 v232, v232
    v_rcp_f32 v233, v233
    v_rcp_f32 v234, v234
    v_rcp_f32 v235, v235
    v_rcp_f32 v236, v236
    v_rcp_f32 v237, v237
    v_rcp_f32 v238, v238
    v_rcp_f32 v239, v239
    v_pk_mul_f32 v[232:233], v[232:233], v[72:73]
    v_pk_mul_f32 v[234:235], v[234:235], v[74:75]
    v_pk_mul_f32 v[236:237], v[236:237], v[76:77]
    v_pk_mul_f32 v[238:239], v[238:239], v[78:79]
    v_cvt_pk_bf16_f32 v72, v232, v233
    v_cvt_pk_bf16_f32 v73, v234, v235
    v_cvt_pk_bf16_f32 v74, v236, v237
    v_cvt_pk_bf16_f32 v75, v238, v239
    buffer_store_dwordx4 v[72:75], v2, s[40:43], s14 offen offset:3072 sc1
    s_waitcnt vmcnt(4)
    s_barrier
    ds_read_b64_tr_b16 v[12:13], v220 offset:0
    ds_read_b64_tr_b16 v[14:15], v220 offset:512
    ds_read_b64_tr_b16 v[16:17], v221 offset:0
    ds_read_b64_tr_b16 v[18:19], v221 offset:512
    ds_read_b64_tr_b16 v[20:21], v220 offset:2048
    ds_read_b64_tr_b16 v[22:23], v220 offset:2560
    ds_read_b64_tr_b16 v[24:25], v221 offset:2048
    ds_read_b64_tr_b16 v[26:27], v221 offset:2560
    ds_read_b64_tr_b16 v[28:29], v220 offset:4096
    ds_read_b64_tr_b16 v[30:31], v220 offset:4608
    ds_read_b64_tr_b16 v[32:33], v221 offset:4096
    ds_read_b64_tr_b16 v[34:35], v221 offset:4608
    v_mfma_f32_32x32x16_bf16 v[80:95], v[172:175], v[180:183], 0
    v_mfma_f32_32x32x16_bf16 v[96:111], v[176:179], v[180:183], 0
    s_waitcnt lgkmcnt(10)
    v_mfma_f32_32x32x16_bf16 v[80:95], v[12:15], a[0:3], v[80:95]
    ds_read_b64_tr_b16 v[36:37], v220 offset:6144
    ds_read_b64_tr_b16 v[38:39], v220 offset:6656
    ds_read_b64_tr_b16 v[40:41], v221 offset:6144
    ds_read_b64_tr_b16 v[42:43], v221 offset:6656
    s_waitcnt lgkmcnt(12)
    v_mfma_f32_32x32x16_bf16 v[96:111], v[16:19], a[0:3], v[96:111]
    s_add_u32 m0, s58, 8192
    s_add_u32 s51, s100, 57344
    buffer_load_dwordx4 v184, s[28:31], s51 offen lds
    s_waitcnt lgkmcnt(10)
    v_mfma_f32_32x32x16_bf16 v[80:95], v[20:23], a[4:7], v[80:95]
    ds_read_b64_tr_b16 v[12:13], v220 offset:8192
    ds_read_b64_tr_b16 v[14:15], v220 offset:8704
    ds_read_b64_tr_b16 v[16:17], v221 offset:8192
    s_waitcnt lgkmcnt(11)
    v_mfma_f32_32x32x16_bf16 v[96:111], v[24:27], a[4:7], v[96:111]
    ds_read_b64_tr_b16 v[18:19], v221 offset:8704
    buffer_load_dwordx4 v185, s[28:31], s51 offen offset:1024 lds
    s_waitcnt lgkmcnt(10)
    v_mfma_f32_32x32x16_bf16 v[80:95], v[28:31], a[8:11], v[80:95]
    ds_read_b64_tr_b16 v[20:21], v220 offset:10240
    ds_read_b64_tr_b16 v[22:23], v220 offset:10752
    ds_read_b64_tr_b16 v[24:25], v221 offset:10240
    s_waitcnt lgkmcnt(11)
    v_mfma_f32_32x32x16_bf16 v[96:111], v[32:35], a[8:11], v[96:111]
    ds_read_b64_tr_b16 v[26:27], v221 offset:10752
    buffer_load_dwordx4 v186, s[28:31], s51 offen offset:2048 lds
    s_waitcnt lgkmcnt(10)
    v_mfma_f32_32x32x16_bf16 v[80:95], v[36:39], a[12:15], v[80:95]
    ds_read_b64_tr_b16 v[28:29], v220 offset:12288
    ds_read_b64_tr_b16 v[30:31], v220 offset:12800
    ds_read_b64_tr_b16 v[32:33], v221 offset:12288
    s_waitcnt lgkmcnt(11)
    v_mfma_f32_32x32x16_bf16 v[96:111], v[40:43], a[12:15], v[96:111]
    ds_read_b64_tr_b16 v[34:35], v221 offset:12800
    buffer_load_dwordx4 v187, s[28:31], s51 offen offset:3072 lds
    s_waitcnt lgkmcnt(10)
    v_mfma_f32_32x32x16_bf16 v[80:95], v[12:15], a[16:19], v[80:95]
    ds_read_b64_tr_b16 v[36:37], v220 offset:14336
    ds_read_b64_tr_b16 v[38:39], v220 offset:14848
    ds_read_b64_tr_b16 v[40:41], v221 offset:14336
    ds_read_b64_tr_b16 v[42:43], v221 offset:14848
    s_waitcnt lgkmcnt(12)
    v_mfma_f32_32x32x16_bf16 v[96:111], v[16:19], a[16:19], v[96:111]
    s_add_u32 m0, s59, 57344
    s_add_u32 s51, s100, 86016
    buffer_load_dwordx4 v184, s[28:31], s51 offen lds
    s_waitcnt lgkmcnt(10)
    v_mfma_f32_32x32x16_bf16 v[80:95], v[20:23], a[20:23], v[80:95]
    ds_read_b64_tr_b16 v[12:13], v220 offset:16384
    ds_read_b64_tr_b16 v[14:15], v220 offset:16896
    ds_read_b64_tr_b16 v[16:17], v221 offset:16384
    s_waitcnt lgkmcnt(11)
    v_mfma_f32_32x32x16_bf16 v[96:111], v[24:27], a[20:23], v[96:111]
    ds_read_b64_tr_b16 v[18:19], v221 offset:16896
    buffer_load_dwordx4 v185, s[28:31], s51 offen offset:1024 lds
    s_waitcnt lgkmcnt(10)
    v_mfma_f32_32x32x16_bf16 v[80:95], v[28:31], a[24:27], v[80:95]
    ds_read_b64_tr_b16 v[20:21], v220 offset:18432
    ds_read_b64_tr_b16 v[22:23], v220 offset:18944
    ds_read_b64_tr_b16 v[24:25], v221 offset:18432
    s_waitcnt lgkmcnt(11)
    v_mfma_f32_32x32x16_bf16 v[96:111], v[32:35], a[24:27], v[96:111]
    ds_read_b64_tr_b16 v[26:27], v221 offset:18944
    buffer_load_dwordx4 v186, s[28:31], s51 offen offset:2048 lds
    s_waitcnt lgkmcnt(10)
    v_mfma_f32_32x32x16_bf16 v[80:95], v[36:39], a[28:31], v[80:95]
    ds_read_b64_tr_b16 v[28:29], v220 offset:20480
    ds_read_b64_tr_b16 v[30:31], v220 offset:20992
    ds_read_b64_tr_b16 v[32:33], v221 offset:20480
    s_waitcnt lgkmcnt(11)
    v_mfma_f32_32x32x16_bf16 v[96:111], v[40:43], a[28:31], v[96:111]
    ds_read_b64_tr_b16 v[34:35], v221 offset:20992
    buffer_load_dwordx4 v187, s[28:31], s51 offen offset:3072 lds
    s_waitcnt lgkmcnt(10)
    v_mfma_f32_32x32x16_bf16 v[80:95], v[12:15], a[32:35], v[80:95]
    ds_read_b64_tr_b16 v[36:37], v220 offset:22528
    ds_read_b64_tr_b16 v[38:39], v220 offset:23040
    ds_read_b64_tr_b16 v[40:41], v221 offset:22528
    ds_read_b64_tr_b16 v[42:43], v221 offset:23040
    s_waitcnt lgkmcnt(12)
    v_mfma_f32_32x32x16_bf16 v[96:111], v[16:19], a[32:35], v[96:111]
    s_add_u32 m0, s59, 61440
    s_add_u32 s51, s100, 114688
    buffer_load_dwordx4 v184, s[28:31], s51 offen lds
    s_waitcnt lgkmcnt(10)
    v_mfma_f32_32x32x16_bf16 v[80:95], v[20:23], a[36:39], v[80:95]
    ds_read_b64_tr_b16 v[12:13], v220 offset:24576
    ds_read_b64_tr_b16 v[14:15], v220 offset:25088
    ds_read_b64_tr_b16 v[16:17], v221 offset:24576
    s_waitcnt lgkmcnt(11)
    v_mfma_f32_32x32x16_bf16 v[96:111], v[24:27], a[36:39], v[96:111]
    ds_read_b64_tr_b16 v[18:19], v221 offset:25088
    buffer_load_dwordx4 v185, s[28:31], s51 offen offset:1024 lds
    s_waitcnt lgkmcnt(10)
    v_mfma_f32_32x32x16_bf16 v[80:95], v[28:31], a[40:43], v[80:95]
    ds_read_b64_tr_b16 v[20:21], v220 offset:26624
    ds_read_b64_tr_b16 v[22:23], v220 offset:27136
    s_waitcnt lgkmcnt(10)
    v_mfma_f32_32x32x16_bf16 v[96:111], v[32:35], a[40:43], v[96:111]
    ds_read_b64_tr_b16 v[24:25], v221 offset:26624
    ds_read_b64_tr_b16 v[26:27], v221 offset:27136
    s_waitcnt vmcnt(10)
    s_mov_b64 exec, 1
    buffer_store_dword v254, v10, s[24:27], s13 offen
    buffer_store_dword v254, v10, s[4:7], s13 offen sc1
    s_mov_b64 exec, -1
    s_add_u32 s13, s13, 131072
    s_waitcnt lgkmcnt(10)
    v_mfma_f32_32x32x16_bf16 v[80:95], v[36:39], a[44:47], v[80:95]
    ds_read_b64_tr_b16 v[28:29], v220 offset:28672
    ds_read_b64_tr_b16 v[30:31], v220 offset:29184
    ds_read_b64_tr_b16 v[32:33], v221 offset:28672
    s_waitcnt lgkmcnt(11)
    v_mfma_f32_32x32x16_bf16 v[96:111], v[40:43], a[44:47], v[96:111]
    ds_read_b64_tr_b16 v[34:35], v221 offset:29184
    buffer_load_dwordx4 v186, s[28:31], s51 offen offset:2048 lds
    s_waitcnt lgkmcnt(10)
    v_mfma_f32_32x32x16_bf16 v[80:95], v[12:15], a[48:51], v[80:95]
    ds_read_b64_tr_b16 v[36:37], v220 offset:30720
    ds_read_b64_tr_b16 v[38:39], v220 offset:31232
    ds_read_b64_tr_b16 v[40:41], v221 offset:30720
    s_waitcnt lgkmcnt(11)
    v_mfma_f32_32x32x16_bf16 v[96:111], v[16:19], a[48:51], v[96:111]
    ds_read_b64_tr_b16 v[42:43], v221 offset:31232
    buffer_load_dwordx4 v187, s[28:31], s51 offen offset:3072 lds
    s_waitcnt lgkmcnt(10)
    v_mfma_f32_32x32x16_bf16 v[80:95], v[20:23], a[52:55], v[80:95]
    ds_read_b64_tr_b16 v[12:13], v220 offset:32768
    ds_read_b64_tr_b16 v[14:15], v220 offset:33280
    ds_read_b64_tr_b16 v[16:17], v221 offset:32768
    ds_read_b64_tr_b16 v[18:19], v221 offset:33280
    s_waitcnt lgkmcnt(12)
    v_mfma_f32_32x32x16_bf16 v[96:111], v[24:27], a[52:55], v[96:111]
    s_add_u32 m0, s59, 65536
    s_add_u32 s51, s100, 143360
    buffer_load_dwordx4 v184, s[28:31], s51 offen lds
    s_waitcnt lgkmcnt(10)
    v_mfma_f32_32x32x16_bf16 v[80:95], v[28:31], a[56:59], v[80:95]
    ds_read_b64_tr_b16 v[20:21], v220 offset:34816
    ds_read_b64_tr_b16 v[22:23], v220 offset:35328
    ds_read_b64_tr_b16 v[24:25], v221 offset:34816
    s_waitcnt lgkmcnt(11)
    v_mfma_f32_32x32x16_bf16 v[96:111], v[32:35], a[56:59], v[96:111]
    ds_read_b64_tr_b16 v[26:27], v221 offset:35328
    buffer_load_dwordx4 v185, s[28:31], s51 offen offset:1024 lds
    s_waitcnt lgkmcnt(10)
    v_mfma_f32_32x32x16_bf16 v[80:95], v[36:39], a[60:63], v[80:95]
    ds_read_b64_tr_b16 v[28:29], v220 offset:36864
    ds_read_b64_tr_b16 v[30:31], v220 offset:37376
    ds_read_b64_tr_b16 v[32:33], v221 offset:36864
    s_waitcnt lgkmcnt(11)
    v_mfma_f32_32x32x16_bf16 v[96:111], v[40:43], a[60:63], v[96:111]
    ds_read_b64_tr_b16 v[34:35], v221 offset:37376
    buffer_load_dwordx4 v186, s[28:31], s51 offen offset:2048 lds
    s_waitcnt lgkmcnt(10)
    v_mfma_f32_32x32x16_bf16 v[80:95], v[12:15], a[64:67], v[80:95]
    ds_read_b64_tr_b16 v[36:37], v220 offset:38912
    ds_read_b64_tr_b16 v[38:39], v220 offset:39424
    ds_read_b64_tr_b16 v[40:41], v221 offset:38912
    s_waitcnt lgkmcnt(11)
    v_mfma_f32_32x32x16_bf16 v[96:111], v[16:19], a[64:67], v[96:111]
    ds_read_b64_tr_b16 v[42:43], v221 offset:39424
    buffer_load_dwordx4 v187, s[28:31], s51 offen offset:3072 lds
    s_waitcnt lgkmcnt(10)
    v_mfma_f32_32x32x16_bf16 v[80:95], v[20:23], a[68:71], v[80:95]
    ds_read_b64_tr_b16 v[12:13], v220 offset:40960
    ds_read_b64_tr_b16 v[14:15], v220 offset:41472
    s_waitcnt lgkmcnt(10)
    v_mfma_f32_32x32x16_bf16 v[96:111], v[24:27], a[68:71], v[96:111]
    ds_read_b64_tr_b16 v[16:17], v221 offset:40960
    ds_read_b64_tr_b16 v[18:19], v221 offset:41472
    s_waitcnt lgkmcnt(10)
    v_mfma_f32_32x32x16_bf16 v[80:95], v[28:31], a[72:75], v[80:95]
    ds_read_b64_tr_b16 v[20:21], v220 offset:43008
    ds_read_b64_tr_b16 v[22:23], v220 offset:43520
    s_waitcnt lgkmcnt(10)
    v_mfma_f32_32x32x16_bf16 v[96:111], v[32:35], a[72:75], v[96:111]
    ds_read_b64_tr_b16 v[24:25], v221 offset:43008
    ds_read_b64_tr_b16 v[26:27], v221 offset:43520
    s_waitcnt lgkmcnt(10)
    v_mfma_f32_32x32x16_bf16 v[80:95], v[36:39], a[76:79], v[80:95]
    ds_read_b64_tr_b16 v[28:29], v220 offset:45056
    ds_read_b64_tr_b16 v[30:31], v220 offset:45568
    s_waitcnt lgkmcnt(10)
    v_mfma_f32_32x32x16_bf16 v[96:111], v[40:43], a[76:79], v[96:111]
    ds_read_b64_tr_b16 v[32:33], v221 offset:45056
    ds_read_b64_tr_b16 v[34:35], v221 offset:45568
    s_waitcnt lgkmcnt(10)
    v_mfma_f32_32x32x16_bf16 v[80:95], v[12:15], a[80:83], v[80:95]
    ds_read_b64_tr_b16 v[36:37], v220 offset:47104
    ds_read_b64_tr_b16 v[38:39], v220 offset:47616
    s_waitcnt lgkmcnt(10)
    v_mfma_f32_32x32x16_bf16 v[96:111], v[16:19], a[80:83], v[96:111]
    ds_read_b64_tr_b16 v[40:41], v221 offset:47104
    ds_read_b64_tr_b16 v[42:43], v221 offset:47616
    s_waitcnt lgkmcnt(10)
    v_mfma_f32_32x32x16_bf16 v[80:95], v[20:23], a[84:87], v[80:95]
    ds_read_b64_tr_b16 v[12:13], v220 offset:49152
    ds_read_b64_tr_b16 v[14:15], v220 offset:49664
    s_waitcnt lgkmcnt(10)
    v_mfma_f32_32x32x16_bf16 v[96:111], v[24:27], a[84:87], v[96:111]
    ds_read_b64_tr_b16 v[16:17], v221 offset:49152
    ds_read_b64_tr_b16 v[18:19], v221 offset:49664
    s_waitcnt lgkmcnt(10)
    v_mfma_f32_32x32x16_bf16 v[80:95], v[28:31], a[88:91], v[80:95]
    ds_read_b64_tr_b16 v[20:21], v220 offset:51200
    ds_read_b64_tr_b16 v[22:23], v220 offset:51712
    s_waitcnt lgkmcnt(10)
    v_mfma_f32_32x32x16_bf16 v[96:111], v[32:35], a[88:91], v[96:111]
    ds_read_b64_tr_b16 v[24:25], v221 offset:51200
    ds_read_b64_tr_b16 v[26:27], v221 offset:51712
    s_waitcnt lgkmcnt(10)
    v_mfma_f32_32x32x16_bf16 v[80:95], v[36:39], a[92:95], v[80:95]
    ds_read_b64_tr_b16 v[28:29], v220 offset:53248
    ds_read_b64_tr_b16 v[30:31], v220 offset:53760
    s_waitcnt lgkmcnt(10)
    v_mfma_f32_32x32x16_bf16 v[96:111], v[40:43], a[92:95], v[96:111]
    ds_read_b64_tr_b16 v[32:33], v221 offset:53248
    ds_read_b64_tr_b16 v[34:35], v221 offset:53760
    s_waitcnt lgkmcnt(10)
    v_mfma_f32_32x32x16_bf16 v[80:95], v[12:15], a[96:99], v[80:95]
    ds_read_b64_tr_b16 v[36:37], v220 offset:55296
    ds_read_b64_tr_b16 v[38:39], v220 offset:55808
    s_waitcnt lgkmcnt(10)
    v_mfma_f32_32x32x16_bf16 v[96:111], v[16:19], a[96:99], v[96:111]
    ds_read_b64_tr_b16 v[40:41], v221 offset:55296
    ds_read_b64_tr_b16 v[42:43], v221 offset:55808
    s_waitcnt lgkmcnt(10)
    v_mfma_f32_32x32x16_bf16 v[80:95], v[20:23], a[100:103], v[80:95]
    s_waitcnt lgkmcnt(8)
    v_mfma_f32_32x32x16_bf16 v[96:111], v[24:27], a[100:103], v[96:111]
    s_waitcnt lgkmcnt(6)
    v_mfma_f32_32x32x16_bf16 v[80:95], v[28:31], a[104:107], v[80:95]
    s_waitcnt lgkmcnt(4)
    v_mfma_f32_32x32x16_bf16 v[96:111], v[32:35], a[104:107], v[96:111]
    s_waitcnt lgkmcnt(2)
    v_mfma_f32_32x32x16_bf16 v[80:95], v[36:39], a[108:111], v[80:95]
    s_waitcnt lgkmcnt(0)
    v_mfma_f32_32x32x16_bf16 v[96:111], v[40:43], a[108:111], v[96:111]
    s_barrier
    buffer_load_dword v215, v242, s[40:43], s12 offen sc1
    s_nop 7
    v_pk_mul_f32 v[232:233], v[80:81], v[80:81]
    v_pk_mul_f32 v[234:235], v[82:83], v[82:83]
    v_pk_mul_f32 v[236:237], v[84:85], v[84:85]
    v_pk_mul_f32 v[238:239], v[86:87], v[86:87]
    v_pk_fma_f32 v[232:233], v[232:233], v[226:227], v[224:225] op_sel_hi:[1,0,0]
    v_pk_fma_f32 v[234:235], v[234:235], v[226:227], v[224:225] op_sel_hi:[1,0,0]
    v_pk_fma_f32 v[236:237], v[236:237], v[226:227], v[224:225] op_sel_hi:[1,0,0]
    v_pk_fma_f32 v[238:239], v[238:239], v[226:227], v[224:225] op_sel_hi:[1,0,0]
    v_pk_mul_f32 v[232:233], v[232:233], v[80:81]
    v_pk_mul_f32 v[234:235], v[234:235], v[82:83]
    v_pk_mul_f32 v[236:237], v[236:237], v[84:85]
    v_pk_mul_f32 v[238:239], v[238:239], v[86:87]
    v_exp_f32 v232, v232
    v_exp_f32 v233, v233
    v_exp_f32 v234, v234
    v_exp_f32 v235, v235
    v_exp_f32 v236, v236
    v_exp_f32 v237, v237
    v_exp_f32 v238, v238
    v_exp_f32 v239, v239
    v_pk_fma_f32 v[232:233], v[232:233], v[228:229], v[228:229] op_sel_hi:[1,0,0]
    v_pk_fma_f32 v[234:235], v[234:235], v[228:229], v[228:229] op_sel_hi:[1,0,0]
    v_pk_fma_f32 v[236:237], v[236:237], v[228:229], v[228:229] op_sel_hi:[1,0,0]
    v_pk_fma_f32 v[238:239], v[238:239], v[228:229], v[228:229] op_sel_hi:[1,0,0]
    v_rcp_f32 v232, v232
    v_rcp_f32 v233, v233
    v_rcp_f32 v234, v234
    v_rcp_f32 v235, v235
    v_rcp_f32 v236, v236
    v_rcp_f32 v237, v237
    v_rcp_f32 v238, v238
    v_rcp_f32 v239, v239
    v_pk_mul_f32 v[232:233], v[232:233], v[80:81]
    v_pk_mul_f32 v[234:235], v[234:235], v[82:83]
    v_pk_mul_f32 v[236:237], v[236:237], v[84:85]
    v_pk_mul_f32 v[238:239], v[238:239], v[86:87]
    v_cvt_pk_bf16_f32 v80, v232, v233
    v_cvt_pk_bf16_f32 v81, v234, v235
    v_cvt_pk_bf16_f32 v82, v236, v237
    v_cvt_pk_bf16_f32 v83, v238, v239
    buffer_store_dwordx4 v[80:83], v2, s[40:43], s15 offen offset:0 sc1
    s_waitcnt vmcnt(1)
    v_cmp_ne_u32 vcc, s101, v215
    s_nop 0
    s_cbranch_vccz L_pollD0ok_8
    s_mov_b32 s54, 0x40000
L_pollD0_9:
    buffer_load_dword v215, v242, s[40:43], s12 offen sc1
    s_sub_u32 s54, s54, 1
    s_waitcnt vmcnt(0)
    s_cbranch_scc1 L_pollD0_9_x
    v_cmp_ne_u32 vcc, s101, v215
    s_nop 0
    s_cbranch_vccnz L_pollD0_9
L_pollD0_9_x:
L_pollD0ok_8:
    s_add_u32 s12, s12, 131072
    v_pk_mul_f32 v[232:233], v[88:89], v[88:89]
    v_pk_mul_f32 v[234:235], v[90:91], v[90:91]
    v_pk_mul_f32 v[236:237], v[92:93], v[92:93]
    v_pk_mul_f32 v[238:239], v[94:95], v[94:95]
    v_pk_fma_f32 v[232:233], v[232:233], v[226:227], v[224:225] op_sel_hi:[1,0,0]
    v_pk_fma_f32 v[234:235], v[234:235], v[226:227], v[224:225] op_sel_hi:[1,0,0]
    v_pk_fma_f32 v[236:237], v[236:237], v[226:227], v[224:225] op_sel_hi:[1,0,0]
    v_pk_fma_f32 v[238:239], v[238:239], v[226:227], v[224:225] op_sel_hi:[1,0,0]
    s_add_u32 s48, s98, 0
    buffer_load_dwordx4 a[0:3], v240, s[40:43], s48 offen offset:0 sc1
    v_pk_mul_f32 v[232:233], v[232:233], v[88:89]
    v_pk_mul_f32 v[234:235], v[234:235], v[90:91]
    v_pk_mul_f32 v[236:237], v[236:237], v[92:93]
    v_pk_mul_f32 v[238:239], v[238:239], v[94:95]
    v_exp_f32 v232, v232
    v_exp_f32 v233, v233
    v_exp_f32 v234, v234
    v_exp_f32 v235, v235
    buffer_load_dwordx4 a[4:7], v241, s[40:43], s48 offen offset:0 sc1
    v_exp_f32 v236, v236
    v_exp_f32 v237, v237
    v_exp_f32 v238, v238
    v_exp_f32 v239, v239
    v_pk_fma_f32 v[232:233], v[232:233], v[228:229], v[228:229] op_sel_hi:[1,0,0]
    v_pk_fma_f32 v[234:235], v[234:235], v[228:229], v[228:229] op_sel_hi:[1,0,0]
    v_pk_fma_f32 v[236:237], v[236:237], v[228:229], v[228:229] op_sel_hi:[1,0,0]
    v_pk_fma_f32 v[238:239], v[238:239], v[228:229], v[228:229] op_sel_hi:[1,0,0]
    buffer_load_dwordx4 a[8:11], v240, s[40:43], s48 offen offset:1024 sc1
    v_rcp_f32 v232, v232
    v_rcp_f32 v233, v233
    v_rcp_f32 v234, v234
    v_rcp_f32 v235, v235
    v_rcp_f32 v236, v236
    v_rcp_f32 v237, v237
    v_rcp_f32 v238, v238
    v_rcp_f32 v239, v239
    buffer_load_dwordx4 a[12:15], v241, s[40:43], s48 offen offset:1024 sc1
    v_pk_mul_f32 v[232:233], v[232:233], v[88:89]
    v_pk_mul_f32 v[234:235], v[234:235], v[90:91]
    v_pk_mul_f32 v[236:237], v[236:237], v[92:93]
    v_pk_mul_f32 v[238:239], v[238:239], v[94:95]
    v_cvt_pk_bf16_f32 v88, v232, v233
    v_cvt_pk_bf16_f32 v89, v234, v235
    v_cvt_pk_bf16_f32 v90, v236, v237
    v_cvt_pk_bf16_f32 v91, v238, v239
    buffer_load_dwordx4 a[16:19], v240, s[40:43], s48 offen offset:2048 sc1
    buffer_store_dwordx4 v[88:91], v2, s[40:43], s15 offen offset:1024 sc1
    v_pk_mul_f32 v[232:233], v[96:97], v[96:97]
    v_pk_mul_f32 v[234:235], v[98:99], v[98:99]
    v_pk_mul_f32 v[236:237], v[100:101], v[100:101]
    v_pk_mul_f32 v[238:239], v[102:103], v[102:103]
    v_pk_fma_f32 v[232:233], v[232:233], v[226:227], v[224:225] op_sel_hi:[1,0,0]
    v_pk_fma_f32 v[234:235], v[234:235], v[226:227], v[224:225] op_sel_hi:[1,0,0]
    v_pk_fma_f32 v[236:237], v[236:237], v[226:227], v[224:225] op_sel_hi:[1,0,0]
    buffer_load_dwordx4 a[20:23], v241, s[40:43], s48 offen offset:2048 sc1
    v_pk_fma_f32 v[238:239], v[238:239], v[226:227], v[224:225] op_sel_hi:[1,0,0]
    v_pk_mul_f32 v[232:233], v[232:233], v[96:97]
    v_pk_mul_f32 v[234:235], v[234:235], v[98:99]
    v_pk_mul_f32 v[236:237], v[236:237], v[100:101]
    v_pk_mul_f32 v[238:239], v[238:239], v[102:103]
    v_exp_f32 v232, v232
    v_exp_f32 v233, v233
    v_exp_f32 v234, v234
    buffer_load_dwordx4 a[24:27], v240, s[40:43], s48 offen offset:3072 sc1
    v_exp_f32 v235, v235
    v_exp_f32 v236, v236
    v_exp_f32 v237, v237
    v_exp_f32 v238, v238
    v_exp_f32 v239, v239
    v_pk_fma_f32 v[232:233], v[232:233], v[228:229], v[228:229] op_sel_hi:[1,0,0]
    v_pk_fma_f32 v[234:235], v[234:235], v[228:229], v[228:229] op_sel_hi:[1,0,0]
    v_pk_fma_f32 v[236:237], v[236:237], v[228:229], v[228:229] op_sel_hi:[1,0,0]
    buffer_load_dwordx4 a[28:31], v241, s[40:43], s48 offen offset:3072 sc1
    v_pk_fma_f32 v[238:239], v[238:239], v[228:229], v[228:229] op_sel_hi:[1,0,0]
    v_rcp_f32 v232, v232
    v_rcp_f32 v233, v233
    v_rcp_f32 v234, v234
    v_rcp_f32 v235, v235
    v_rcp_f32 v236, v236
    v_rcp_f32 v237, v237
    v_rcp_f32 v238, v238
    s_add_u32 s48, s98, 4096
    buffer_load_dwordx4 a[32:35], v240, s[40:43], s48 offen offset:0 sc1
    v_rcp_f32 v239, v239
    v_pk_mul_f32 v[232:233], v[232:233], v[96:97]
    v_pk_mul_f32 v[234:235], v[234:235], v[98:99]
    v_pk_mul_f32 v[236:237], v[236:237], v[100:101]
    v_pk_mul_f32 v[238:239], v[238:239], v[102:103]
    v_cvt_pk_bf16_f32 v96, v232, v233
    v_cvt_pk_bf16_f32 v97, v234, v235
    v_cvt_pk_bf16_f32 v98, v236, v237
    buffer_load_dwordx4 a[36:39], v241, s[40:43], s48 offen offset:0 sc1
    v_cvt_pk_bf16_f32 v99, v238, v239
    buffer_store_dwordx4 v[96:99], v2, s[40:43], s15 offen offset:2048 sc1
    v_pk_mul_f32 v[232:233], v[104:105], v[104:105]
    v_pk_mul_f32 v[234:235], v[106:107], v[106:107]
    v_pk_mul_f32 v[236:237], v[108:109], v[108:109]
    v_pk_mul_f32 v[238:239], v[110:111], v[110:111]
    v_pk_fma_f32 v[232:233], v[232:233], v[226:227], v[224:225] op_sel_hi:[1,0,0]
    v_pk_fma_f32 v[234:235], v[234:235], v[226:227], v[224:225] op_sel_hi:[1,0,0]
    buffer_load_dwordx4 a[40:43], v240, s[40:43], s48 offen offset:1024 sc1
    v_pk_fma_f32 v[236:237], v[236:237], v[226:227], v[224:225] op_sel_hi:[1,0,0]
    v_pk_fma_f32 v[238:239], v[238:239], v[226:227], v[224:225] op_sel_hi:[1,0,0]
    v_pk_mul_f32 v[232:233], v[232:233], v[104:105]
    v_pk_mul_f32 v[234:235], v[234:235], v[106:107]
    v_pk_mul_f32 v[236:237], v[236:237], v[108:109]
    v_pk_mul_f32 v[238:239], v[238:239], v[110:111]
    v_exp_f32 v232, v232
    v_exp_f32 v233, v233
    buffer_load_dwordx4 a[44:47], v241, s[40:43], s48 offen offset:1024 sc1
    v_exp_f32 v234, v234
    v_exp_f32 v235, v235
    v_exp_f32 v236, v236
    v_exp_f32 v237, v237
    v_exp_f32 v238, v238
    v_exp_f32 v239, v239
    v_pk_fma_f32 v[232:233], v[232:233], v[228:229], v[228:229] op_sel_hi:[1,0,0]
    v_pk_fma_f32 v[234:235], v[234:235], v[228:229], v[228:229] op_sel_hi:[1,0,0]
    buffer_load_dwordx4 a[48:51], v240, s[40:43], s48 offen offset:2048 sc1
    v_pk_fma_f32 v[236:237], v[236:237], v[228:229], v[228:229] op_sel_hi:[1,0,0]
    v_pk_fma_f32 v[238:239], v[238:239], v[228:229], v[228:229] op_sel_hi:[1,0,0]
    v_rcp_f32 v232, v232
    v_rcp_f32 v233, v233
    v_rcp_f32 v234, v234
    v_rcp_f32 v235, v235
    v_rcp_f32 v236, v236
    v_rcp_f32 v237, v237
    buffer_load_dwordx4 a[52:55], v241, s[40:43], s48 offen offset:2048 sc1
    v_rcp_f32 v238, v238
    v_rcp_f32 v239, v239
    v_pk_mul_f32 v[232:233], v[232:233], v[104:105]
    v_pk_mul_f32 v[234:235], v[234:235], v[106:107]
    v_pk_mul_f32 v[236:237], v[236:237], v[108:109]
    v_pk_mul_f32 v[238:239], v[238:239], v[110:111]
    v_cvt_pk_bf16_f32 v104, v232, v233
    v_cvt_pk_bf16_f32 v105, v234, v235
    v_cvt_pk_bf16_f32 v106, v236, v237
    v_cvt_pk_bf16_f32 v107, v238, v239
    buffer_store_dwordx4 v[104:107], v2, s[40:43], s15 offen offset:3072 sc1
    ds_read_b64_tr_b16 v[12:13], v216 offset:0
    ds_read_b64_tr_b16 v[14:15], v216 offset:512
    ds_read_b64_tr_b16 v[16:17], v217 offset:0
    ds_read_b64_tr_b16 v[18:19], v217 offset:512
    ds_read_b64_tr_b16 v[20:21], v216 offset:2048
    ds_read_b64_tr_b16 v[22:23], v216 offset:2560
    ds_read_b64_tr_b16 v[24:25], v217 offset:2048
    ds_read_b64_tr_b16 v[26:27], v217 offset:2560
    s_waitcnt vmcnt(15) lgkmcnt(4)
    v_mfma_f32_32x32x16_bf16 v[196:211], v[16:19], a[4:7], 0
    buffer_load_dwordx4 a[56:59], v240, s[40:43], s48 offen offset:3072 sc1
    v_mfma_f32_32x32x16_bf16 v[64:79], v[12:15], a[4:7], 0
    buffer_load_dwordx4 a[60:63], v241, s[40:43], s48 offen offset:3072 sc1
    v_mfma_f32_32x32x16_bf16 v[48:63], v[16:19], a[0:3], 0
    ds_read_b64_tr_b16 v[28:29], v216 offset:4096
    ds_read_b64_tr_b16 v[30:31], v216 offset:4608
    v_mfma_f32_32x32x16_bf16 v[112:127], v[12:15], a[0:3], v[112:127]
    ds_read_b64_tr_b16 v[32:33], v217 offset:4096
    ds_read_b64_tr_b16 v[34:35], v217 offset:4608
    s_waitcnt vmcnt(15) lgkmcnt(4)
    v_mfma_f32_32x32x16_bf16 v[196:211], v[24:27], a[12:15], v[196:211]
    s_add_u32 s48, s98, 8192
    buffer_load_dwordx4 a[64:67], v240, s[40:43], s48 offen offset:0 sc1
    v_mfma_f32_32x32x16_bf16 v[64:79], v[20:23], a[12:15], v[64:79]
    buffer_load_dwordx4 a[68:71], v241, s[40:43], s48 offen offset:0 sc1
    v_mfma_f32_32x32x16_bf16 v[48:63], v[24:27], a[8:11], v[48:63]
    ds_read_b64_tr_b16 v[36:37], v216 offset:6144
    ds_read_b64_tr_b16 v[38:39], v216 offset:6656
    v_mfma_f32_32x32x16_bf16 v[112:127], v[20:23], a[8:11], v[112:127]
    ds_read_b64_tr_b16 v[40:41], v217 offset:6144
    ds_read_b64_tr_b16 v[42:43], v217 offset:6656
    s_waitcnt vmcnt(4)
    s_mov_b64 exec, 1
    buffer_store_dword v254, v10, s[24:27], s13 offen
    buffer_store_dword v254, v10, s[4:7], s13 offen sc1
    s_mov_b64 exec, -1
    s_waitcnt lgkmcnt(4)
    v_mfma_f32_32x32x16_bf16 v[196:211], v[32:35], a[20:23], v[196:211]
    buffer_load_dwordx4 a[72:75], v240, s[40:43], s48 offen offset:1024 sc1
    v_mfma_f32_32x32x16_bf16 v[64:79], v[28:31], a[20:23], v[64:79]
    buffer_load_dwordx4 a[76:79], v241, s[40:43], s48 offen offset:1024 sc1
    v_mfma_f32_32x32x16_bf16 v[48:63], v[32:35], a[16:19], v[48:63]
    ds_read_b64_tr_b16 v[12:13], v216 offset:8192
    ds_read_b64_tr_b16 v[14:15], v216 offset:8704
    v_mfma_f32_32x32x16_bf16 v[112:127], v[28:31], a[16:19], v[112:127]
    ds_read_b64_tr_b16 v[16:17], v217 offset:8192
    ds_read_b64_tr_b16 v[18:19], v217 offset:8704
    s_waitcnt lgkmcnt(4)
    v_mfma_f32_32x32x16_bf16 v[196:211], v[40:43], a[28:31], v[196:211]
    buffer_load_dwordx4 a[80:83], v240, s[40:43], s48 offen offset:2048 sc1
    v_mfma_f32_32x32x16_bf16 v[64:79], v[36:39], a[28:31], v[64:79]
    buffer_load_dwordx4 a[84:87], v241, s[40:43], s48 offen offset:2048 sc1
    v_mfma_f32_32x32x16_bf16 v[48:63], v[40:43], a[24:27], v[48:63]
    ds_read_b64_tr_b16 v[20:21], v216 offset:10240
    ds_read_b64_tr_b16 v[22:23], v216 offset:10752
    v_mfma_f32_32x32x16_bf16 v[112:127], v[36:39], a[24:27], v[112:127]
    ds_read_b64_tr_b16 v[24:25], v217 offset:10240
    ds_read_b64_tr_b16 v[26:27], v217 offset:10752
    s_waitcnt lgkmcnt(4)
    v_mfma_f32_32x32x16_bf16 v[196:211], v[16:19], a[36:39], v[196:211]
    buffer_load_dwordx4 a[88:91], v240, s[40:43], s48 offen offset:3072 sc1
    v_mfma_f32_32x32x16_bf16 v[64:79], v[12:15], a[36:39], v[64:79]
    buffer_load_dwordx4 a[92:95], v241, s[40:43], s48 offen offset:3072 sc1
    v_mfma_f32_32x32x16_bf16 v[48:63], v[16:19], a[32:35], v[48:63]
    ds_read_b64_tr_b16 v[28:29], v218 offset:0
    ds_read_b64_tr_b16 v[30:31], v218 offset:512
    v_mfma_f32_32x32x16_bf16 v[112:127], v[12:15], a[32:35], v[112:127]
    ds_read_b64_tr_b16 v[32:33], v219 offset:0
    ds_read_b64_tr_b16 v[34:35], v219 offset:512
    s_waitcnt lgkmcnt(4)
    v_mfma_f32_32x32x16_bf16 v[196:211], v[24:27], a[44:47], v[196:211]
    s_add_u32 s48, s98, 12288
    buffer_load_dwordx4 a[96:99], v240, s[40:43], s48 offen offset:0 sc1
    v_mfma_f32_32x32x16_bf16 v[64:79], v[20:23], a[44:47], v[64:79]
    buffer_load_dwordx4 a[100:103], v241, s[40:43], s48 offen offset:0 sc1
    v_mfma_f32_32x32x16_bf16 v[48:63], v[24:27], a[40:43], v[48:63]
    ds_read_b64_tr_b16 v[36:37], v218 offset:2048
    ds_read_b64_tr_b16 v[38:39], v218 offset:2560
    v_mfma_f32_32x32x16_bf16 v[112:127], v[20:23], a[40:43], v[112:127]
    ds_read_b64_tr_b16 v[40:41], v219 offset:2048
    ds_read_b64_tr_b16 v[42:43], v219 offset:2560
    s_waitcnt lgkmcnt(4)
    v_mfma_f32_32x32x16_bf16 v[196:211], v[32:35], a[52:55], v[196:211]
    buffer_load_dwordx4 a[104:107], v240, s[40:43], s48 offen offset:1024 sc1
    v_mfma_f32_32x32x16_bf16 v[64:79], v[28:31], a[52:55], v[64:79]
    buffer_load_dwordx4 a[108:111], v241, s[40:43], s48 offen offset:1024 sc1
    v_mfma_f32_32x32x16_bf16 v[48:63], v[32:35], a[48:51], v[48:63]
    ds_read_b64_tr_b16 v[12:13], v218 offset:4096
    ds_read_b64_tr_b16 v[14:15], v218 offset:4608
    v_mfma_f32_32x32x16_bf16 v[112:127], v[28:31], a[48:51], v[112:127]
    ds_read_b64_tr_b16 v[16:17], v219 offset:4096
    ds_read_b64_tr_b16 v[18:19], v219 offset:4608
    s_waitcnt vmcnt(14) lgkmcnt(4)
    v_mfma_f32_32x32x16_bf16 v[196:211], v[40:43], a[60:63], v[196:211]
    buffer_load_dword v215, v242, s[40:43], s12 offen sc1
    v_mfma_f32_32x32x16_bf16 v[64:79], v[36:39], a[60:63], v[64:79]
    ds_read_b64_tr_b16 v[20:21], v218 offset:6144
    v_mfma_f32_32x32x16_bf16 v[48:63], v[40:43], a[56:59], v[48:63]
    ds_read_b64_tr_b16 v[22:23], v218 offset:6656
    ds_read_b64_tr_b16 v[24:25], v219 offset:6144
    v_mfma_f32_32x32x16_bf16 v[112:127], v[36:39], a[56:59], v[112:127]
    ds_read_b64_tr_b16 v[26:27], v219 offset:6656
    s_waitcnt vmcnt(13) lgkmcnt(4)
    v_mfma_f32_32x32x16_bf16 v[196:211], v[16:19], a[68:71], v[196:211]
    ds_read_b64_tr_b16 v[28:29], v218 offset:8192
    v_mfma_f32_32x32x16_bf16 v[64:79], v[12:15], a[68:71], v[64:79]
    ds_read_b64_tr_b16 v[30:31], v218 offset:8704
    v_mfma_f32_32x32x16_bf16 v[48:63], v[16:19], a[64:67], v[48:63]
    ds_read_b64_tr_b16 v[32:33], v219 offset:8192
    v_mfma_f32_32x32x16_bf16 v[112:127], v[12:15], a[64:67], v[112:127]
    ds_read_b64_tr_b16 v[34:35], v219 offset:8704
    s_waitcnt vmcnt(0)
    v_cmp_ne_u32 vcc, s101, v215
    s_nop 0
    s_cbranch_vccz L_pollD1ok_10
    s_mov_b32 s54, 0x40000
L_pollD1_11:
    buffer_load_dword v215, v242, s[40:43], s12 offen sc1
    s_sub_u32 s54, s54, 1
    s_waitcnt vmcnt(0)
    s_cbranch_scc1 L_pollD1_11_x
    v_cmp_ne_u32 vcc, s101, v215
    s_nop 0
    s_cbranch_vccnz L_pollD1_11
L_pollD1_11_x:
L_pollD1ok_10:
    s_waitcnt lgkmcnt(4)
    v_mfma_f32_32x32x16_bf16 v[196:211], v[24:27], a[76:79], v[196:211]
    s_add_u32 s48, s98, 57344
    buffer_load_dwordx4 a[0:3], v240, s[40:43], s48 offen offset:0 sc1
    buffer_load_dwordx4 a[4:7], v241, s[40:43], s48 offen offset:0 sc1
    v_mfma_f32_32x32x16_bf16 v[64:79], v[20:23], a[76:79], v[64:79]
    buffer_load_dwordx4 a[8:11], v240, s[40:43], s48 offen offset:1024 sc1
    buffer_load_dwordx4 a[12:15], v241, s[40:43], s48 offen offset:1024 sc1
    v_mfma_f32_32x32x16_bf16 v[48:63], v[24:27], a[72:75], v[48:63]
    buffer_load_dwordx4 a[16:19], v240, s[40:43], s48 offen offset:2048 sc1
    buffer_load_dwordx4 a[20:23], v241, s[40:43], s48 offen offset:2048 sc1
    v_mfma_f32_32x32x16_bf16 v[112:127], v[20:23], a[72:75], v[112:127]
    ds_read_b64_tr_b16 v[36:37], v218 offset:10240
    ds_read_b64_tr_b16 v[38:39], v218 offset:10752
    ds_read_b64_tr_b16 v[40:41], v219 offset:10240
    ds_read_b64_tr_b16 v[42:43], v219 offset:10752
    s_waitcnt lgkmcnt(4)
    v_mfma_f32_32x32x16_bf16 v[196:211], v[32:35], a[84:87], v[196:211]
    buffer_load_dwordx4 a[24:27], v240, s[40:43], s48 offen offset:3072 sc1
    v_mfma_f32_32x32x16_bf16 v[64:79], v[28:31], a[84:87], v[64:79]
    v_mfma_f32_32x32x16_bf16 v[48:63], v[32:35], a[80:83], v[48:63]
    buffer_load_dwordx4 a[28:31], v241, s[40:43], s48 offen offset:3072 sc1
    v_mfma_f32_32x32x16_bf16 v[112:127], v[28:31], a[80:83], v[112:127]
    s_waitcnt lgkmcnt(0)
    v_mfma_f32_32x32x16_bf16 v[196:211], v[40:43], a[92:95], v[196:211]
    v_mfma_f32_32x32x16_bf16 v[64:79], v[36:39], a[92:95], v[64:79]
    s_add_u32 s48, s98, 61440
    buffer_load_dwordx4 a[32:35], v240, s[40:43], s48 offen offset:0 sc1
    v_mfma_f32_32x32x16_bf16 v[48:63], v[40:43], a[88:91], v[48:63]
    v_mfma_f32_32x32x16_bf16 v[112:127], v[36:39], a[88:91], v[112:127]
    buffer_load_dwordx4 a[36:39], v241, s[40:43], s48 offen offset:0 sc1
    v_mfma_f32_32x32x16_bf16 v[196:211], a[132:135], a[100:103], v[196:211]
    buffer_load_dwordx4 a[40:43], v240, s[40:43], s48 offen offset:1024 sc1
    v_mfma_f32_32x32x16_bf16 v[64:79], a[128:131], a[100:103], v[64:79]
    v_mfma_f32_32x32x16_bf16 v[48:63], a[132:135], a[96:99], v[48:63]
    buffer_load_dwordx4 a[44:47], v241, s[40:43], s48 offen offset:1024 sc1
    v_mfma_f32_32x32x16_bf16 v[112:127], a[128:131], a[96:99], v[112:127]
    v_mfma_f32_32x32x16_bf16 v[196:211], a[140:143], a[108:111], v[196:211]
    buffer_load_dwordx4 a[48:51], v240, s[40:43], s48 offen offset:2048 sc1
    v_mfma_f32_32x32x16_bf16 v[64:79], a[136:139], a[108:111], v[64:79]
    v_mfma_f32_32x32x16_bf16 v[48:63], a[140:143], a[104:107], v[48:63]
    buffer_load_dwordx4 a[52:55], v241, s[40:43], s48 offen offset:2048 sc1
    v_mfma_f32_32x32x16_bf16 v[112:127], a[136:139], a[104:107], v[112:127]
    s_waitcnt vmcnt(12)
    v_mfma_f32_32x32x16_bf16 v[196:211], a[148:151], a[4:7], v[196:211]
    buffer_load_dwordx4 a[56:59], v240, s[40:43], s48 offen offset:3072 sc1
    v_mfma_f32_32x32x16_bf16 v[64:79], a[144:147], a[4:7], v[64:79]
    v_mfma_f32_32x32x16_bf16 v[48:63], a[148:151], a[0:3], v[48:63]
    buffer_load_dwordx4 a[60:63], v241, s[40:43], s48 offen offset:3072 sc1
    v_mfma_f32_32x32x16_bf16 v[112:127], a[144:147], a[0:3], v[112:127]
    s_waitcnt vmcnt(12)
    v_mfma_f32_32x32x16_bf16 v[196:211], a[156:159], a[12:15], v[196:211]
    v_mfma_f32_32x32x16_bf16 v[64:79], a[152:155], a[12:15], v[64:79]
    s_add_u32 s48, s98, 65536
    buffer_load_dwordx4 a[64:67], v240, s[40:43], s48 offen offset:0 sc1
    v_mfma_f32_32x32x16_bf16 v[48:63], a[156:159], a[8:11], v[48:63]
    v_mfma_f32_32x32x16_bf16 v[112:127], a[152:155], a[8:11], v[112:127]
    buffer_load_dwordx4 a[68:71], v241, s[40:43], s48 offen offset:0 sc1
    s_waitcnt vmcnt(12)
    v_mfma_f32_32x32x16_bf16 v[196:211], a[164:167], a[20:23], v[196:211]
    buffer_load_dwordx4 a[72:75], v240, s[40:43], s48 offen offset:1024 sc1
    v_mfma_f32_32x32x16_bf16 v[64:79], a[160:163], a[20:23], v[64:79]
    v_mfma_f32_32x32x16_bf16 v[48:63], a[164:167], a[16:19], v[48:63]
    buffer_load_dwordx4 a[76:79], v241, s[40:43], s48 offen offset:1024 sc1
    s_waitcnt vmcnt(12)
    v_mfma_f32_32x32x16_bf16 v[196:211], a[172:175], a[28:31], v[196:211]
    buffer_load_dwordx4 a[80:83], v240, s[40:43], s48 offen offset:2048 sc1
    v_mfma_f32_32x32x16_bf16 v[64:79], a[168:171], a[28:31], v[64:79]
    v_mfma_f32_32x32x16_bf16 v[48:63], a[172:175], a[24:27], v[48:63]
    buffer_load_dwordx4 a[84:87], v241, s[40:43], s48 offen offset:2048 sc1
    s_waitcnt vmcnt(12)
    v_mfma_f32_32x32x16_bf16 v[196:211], a[180:183], a[36:39], v[196:211]
    buffer_load_dwordx4 a[88:91], v240, s[40:43], s48 offen offset:3072 sc1
    v_mfma_f32_32x32x16_bf16 v[64:79], a[176:179], a[36:39], v[64:79]
    v_mfma_f32_32x32x16_bf16 v[48:63], a[180:183], a[32:35], v[48:63]
    buffer_load_dwordx4 a[92:95], v241, s[40:43], s48 offen offset:3072 sc1
    s_waitcnt vmcnt(12)
    v_mfma_f32_32x32x16_bf16 v[196:211], a[188:191], a[44:47], v[196:211]
    s_add_u32 s48, s98, 69632
    buffer_load_dwordx4 a[96:99], v240, s[40:43], s48 offen offset:0 sc1
    v_mfma_f32_32x32x16_bf16 v[64:79], a[184:187], a[44:47], v[64:79]
    v_mfma_f32_32x32x16_bf16 v[48:63], a[188:191], a[40:43], v[48:63]
    buffer_load_dwordx4 a[100:103], v241, s[40:43], s48 offen offset:0 sc1
    s_waitcnt vmcnt(12)
    v_mfma_f32_32x32x16_bf16 v[196:211], a[196:199], a[52:55], v[196:211]
    buffer_load_dwordx4 a[104:107], v240, s[40:43], s48 offen offset:1024 sc1
    v_mfma_f32_32x32x16_bf16 v[64:79], a[192:195], a[52:55], v[64:79]
    v_mfma_f32_32x32x16_bf16 v[48:63], a[196:199], a[48:51], v[48:63]
    buffer_load_dwordx4 a[108:111], v241, s[40:43], s48 offen offset:1024 sc1
    s_waitcnt vmcnt(12)
    v_mfma_f32_32x32x16_bf16 v[196:211], a[204:207], a[60:63], v[196:211]
    v_mfma_f32_32x32x16_bf16 v[64:79], a[200:203], a[60:63], v[64:79]
    v_mfma_f32_32x32x16_bf16 v[48:63], a[204:207], a[56:59], v[48:63]
    s_waitcnt vmcnt(10)
    v_mfma_f32_32x32x16_bf16 v[196:211], a[212:215], a[68:71], v[196:211]
    v_mfma_f32_32x32x16_bf16 v[64:79], a[208:211], a[68:71], v[64:79]
    v_mfma_f32_32x32x16_bf16 v[48:63], a[212:215], a[64:67], v[48:63]
    s_waitcnt vmcnt(8)
    v_mfma_f32_32x32x16_bf16 v[196:211], a[220:223], a[76:79], v[196:211]
    v_mfma_f32_32x32x16_bf16 v[64:79], a[216:219], a[76:79], v[64:79]
    v_mfma_f32_32x32x16_bf16 v[48:63], a[220:223], a[72:75], v[48:63]
    s_waitcnt vmcnt(6)
    v_mfma_f32_32x32x16_bf16 v[196:211], a[228:231], a[84:87], v[196:211]
    s_sub_u32 s48, s58, 114688
    s_waitcnt vmcnt(4)
    v_mfma_f32_32x32x16_bf16 v[196:211], a[236:239], a[92:95], v[196:211]
    s_waitcnt vmcnt(2)
    v_mfma_f32_32x32x16_bf16 v[196:211], a[244:247], a[100:103], v[196:211]
    v_add_u32 v4, s48, v2
    s_waitcnt vmcnt(0)
    v_mfma_f32_32x32x16_bf16 v[196:211], a[252:255], a[108:111], v[196:211]
    v_mfma_f32_32x32x16_bf16 v[64:79], a[224:227], a[84:87], v[64:79]
    s_nop 7
    v_mfma_f32_32x32x16_bf16 v[64:79], a[232:235], a[92:95], v[64:79]
    v_mfma_f32_32x32x16_bf16 v[64:79], a[240:243], a[100:103], v[64:79]
    s_nop 0
    ds_write_b128 v194, v[196:199] offset:0
    v_mfma_f32_32x32x16_bf16 v[64:79], a[248:251], a[108:111], v[64:79]
    v_mfma_f32_32x32x16_bf16 v[48:63], a[228:231], a[80:83], v[48:63]
    ds_write_b128 v194, v[200:203] offset:1024
    v_mfma_f32_32x32x16_bf16 v[48:63], a[236:239], a[88:91], v[48:63]
    ds_write_b128 v194, v[204:207] offset:2048
    v_mfma_f32_32x32x16_bf16 v[48:63], a[244:247], a[96:99], v[48:63]
    v_mfma_f32_32x32x16_bf16 v[48:63], a[252:255], a[104:107], v[48:63]
    ds_write_b128 v194, v[208:211] offset:3072
    v_mfma_f32_32x32x16_bf16 v[112:127], a[160:163], a[16:19], v[112:127]
    s_nop 3
    ds_write_b128 v193, v[64:67] offset:0
    v_mfma_f32_32x32x16_bf16 v[112:127], a[168:171], a[24:27], v[112:127]
    ds_write_b128 v193, v[68:71] offset:1024
    v_mfma_f32_32x32x16_bf16 v[112:127], a[176:179], a[32:35], v[112:127]
    ds_write_b128 v193, v[72:75] offset:2048
    v_mfma_f32_32x32x16_bf16 v[112:127], a[184:187], a[40:43], v[112:127]
    ds_write_b128 v193, v[76:79] offset:3072
    v_mfma_f32_32x32x16_bf16 v[112:127], a[192:195], a[48:51], v[112:127]
    ds_write_b128 v192, v[48:51] offset:0
    v_mfma_f32_32x32x16_bf16 v[112:127], a[200:203], a[56:59], v[112:127]
    ds_write_b128 v192, v[52:55] offset:1024
    v_mfma_f32_32x32x16_bf16 v[112:127], a[208:211], a[64:67], v[112:127]
    ds_write_b128 v192, v[56:59] offset:2048
    v_mfma_f32_32x32x16_bf16 v[112:127], a[216:219], a[72:75], v[112:127]
    ds_write_b128 v192, v[60:63] offset:3072
    s_waitcnt lgkmcnt(0)
    s_barrier
    v_mfma_f32_32x32x16_bf16 v[112:127], a[224:227], a[80:83], v[112:127]
    ds_read_b128 v[48:51], v4 offset:0
    ds_read_b128 v[64:67], v4 offset:4096
    ds_read_b128 v[80:83], v4 offset:8192
    v_mfma_f32_32x32x16_bf16 v[112:127], a[232:235], a[88:91], v[112:127]
    ds_read_b128 v[52:55], v4 offset:1024
    ds_read_b128 v[68:71], v4 offset:5120
    ds_read_b128 v[84:87], v4 offset:9216
    v_mfma_f32_32x32x16_bf16 v[112:127], a[240:243], a[96:99], v[112:127]
    ds_read_b128 v[56:59], v4 offset:2048
    ds_read_b128 v[72:75], v4 offset:6144
    ds_read_b128 v[88:91], v4 offset:10240
    v_mfma_f32_32x32x16_bf16 v[112:127], a[248:251], a[104:107], v[112:127]
    ds_read_b128 v[60:63], v4 offset:3072
    ds_read_b128 v[76:79], v4 offset:7168
    ds_read_b128 v[92:95], v4 offset:11264
    s_waitcnt lgkmcnt(10)
    v_pk_add_f32 v[48:49], v[48:49], v[64:65]
    s_waitcnt lgkmcnt(9)
    v_pk_add_f32 v[48:49], v[48:49], v[80:81]
    v_pk_add_f32 v[50:51], v[50:51], v[66:67]
    v_pk_add_f32 v[50:51], v[50:51], v[82:83]
    s_waitcnt lgkmcnt(7)
    v_pk_add_f32 v[52:53], v[52:53], v[68:69]
    s_waitcnt lgkmcnt(6)
    v_pk_add_f32 v[52:53], v[52:53], v[84:85]
    v_pk_add_f32 v[54:55], v[54:55], v[70:71]
    v_pk_add_f32 v[54:55], v[54:55], v[86:87]
    s_waitcnt lgkmcnt(4)
    v_pk_add_f32 v[56:57], v[56:57], v[72:73]
    s_waitcnt lgkmcnt(3)
    v_pk_add_f32 v[56:57], v[56:57], v[88:89]
    v_pk_add_f32 v[58:59], v[58:59], v[74:75]
    v_pk_add_f32 v[58:59], v[58:59], v[90:91]
    s_waitcnt lgkmcnt(1)
    v_pk_add_f32 v[60:61], v[60:61], v[76:77]
    s_waitcnt lgkmcnt(0)
    v_pk_add_f32 v[60:61], v[60:61], v[92:93]
    v_pk_add_f32 v[62:63], v[62:63], v[78:79]
    v_pk_add_f32 v[62:63], v[62:63], v[94:95]
    v_pk_add_f32 v[112:113], v[112:113], v[48:49]
    v_pk_add_f32 v[114:115], v[114:115], v[50:51]
    v_pk_add_f32 v[116:117], v[116:117], v[52:53]
    v_pk_add_f32 v[118:119], v[118:119], v[54:55]
    v_cvt_pk_bf16_f32 v112, v112, v113
    v_cvt_pk_bf16_f32 v113, v114, v115
    v_cvt_pk_bf16_f32 v114, v116, v117
    v_cvt_pk_bf16_f32 v115, v118, v119
    buffer_store_dwordx4 v[112:115], v212, s[36:39], 0 offen offset:0
    v_pk_add_f32 v[120:121], v[120:121], v[56:57]
    v_pk_add_f32 v[122:123], v[122:123], v[58:59]
    v_pk_add_f32 v[124:125], v[124:125], v[60:61]
    v_pk_add_f32 v[126:127], v[126:127], v[62:63]
    v_cvt_pk_bf16_f32 v120, v120, v121
    v_cvt_pk_bf16_f32 v121, v122, v123
    v_cvt_pk_bf16_f32 v122, v124, v125
    v_cvt_pk_bf16_f32 v123, v126, v127
    buffer_store_dwordx4 v[120:123], v212, s[36:39], 0 offen offset:32
L_end:
    s_waitcnt vmcnt(0)
L_exit:
    s_endpgm
L_slow:
    s_mov_b32 s52, 0
    s_mov_b32 s54, 64
    v_mov_b32 v92, 0xff7fffff
L_slow_max:
    buffer_load_dwordx4 a[64:67], v9, s[40:43], s52 offen sc1
    buffer_load_dwordx4 a[68:71], v9, s[40:43], s52 offen offset:1024 sc1
    buffer_load_dwordx4 a[72:75], v7, s[40:43], s52 offen sc1
    buffer_load_dwordx4 a[76:79], v8, s[40:43], s52 offen sc1
    s_add_u32 s52, s52, 57472
    s_waitcnt vmcnt(3)
    v_mfma_f32_32x32x16_bf16 v[44:59], a[64:67], v[12:15], 0
    s_waitcnt vmcnt(2)
    v_mfma_f32_32x32x16_bf16 v[44:59], a[68:71], v[16:19], v[44:59]
    s_nop 11
    v_max3_f32 v92, v92, v44, v45
    v_max3_f32 v92, v92, v46, v47
    v_max3_f32 v92, v92, v48, v49
    v_max3_f32 v92, v92, v50, v51
    v_max3_f32 v92, v92, v52, v53
    v_max3_f32 v92, v92, v54, v55
    v_max3_f32 v92, v92, v56, v57
    v_max3_f32 v92, v92, v58, v59
    s_waitcnt vmcnt(0)
    s_sub_u32 s54, s54, 1
    s_cmp_lg_u32 s54, 0
    s_cbranch_scc1 L_slow_max
    v_mov_b32 v3, v92
    s_nop 1
    v_permlane32_swap_b32 v3, v92
    v_max_f32 v92, v92, v3
    s_mov_b32 s52, 0
    s_mov_b32 s54, 64
    v_sub_f32 v108, 0, v92
    v_mov_b32 v196, 0
    v_sub_f32 v109, 0, v92
    v_mov_b32 v197, 0
    v_sub_f32 v110, 0, v92
    v_mov_b32 v198, 0
    v_sub_f32 v111, 0, v92
    v_mov_b32 v199, 0
    v_sub_f32 v112, 0, v92
    v_mov_b32 v200, 0
    v_sub_f32 v113, 0, v92
    v_mov_b32 v201, 0
    v_sub_f32 v114, 0, v92
    v_mov_b32 v202, 0
    v_sub_f32 v115, 0, v92
    v_mov_b32 v203, 0
    v_sub_f32 v116, 0, v92
    v_mov_b32 v204, 0
    v_sub_f32 v117, 0, v92
    v_mov_b32 v205, 0
    v_sub_f32 v118, 0, v92
    v_mov_b32 v206, 0
    v_sub_f32 v119, 0, v92
    v_mov_b32 v207, 0
    v_sub_f32 v120, 0, v92
    v_mov_b32 v208, 0
    v_sub_f32 v121, 0, v92
    v_mov_b32 v209, 0
    v_sub_f32 v122, 0, v92
    v_mov_b32 v210, 0
    v_sub_f32 v123, 0, v92
    v_mov_b32 v211, 0
L_slow_pv:
    buffer_load_dwordx4 a[64:67], v9, s[40:43], s52 offen sc1
    buffer_load_dwordx4 a[68:71], v9, s[40:43], s52 offen offset:1024 sc1
    buffer_load_dwordx4 a[72:75], v7, s[40:43], s52 offen sc1
    buffer_load_dwordx4 a[76:79], v8, s[40:43], s52 offen sc1
    s_add_u32 s52, s52, 57472
    s_waitcnt vmcnt(3)
    v_mfma_f32_32x32x16_bf16 v[44:59], a[64:67], v[12:15], v[108:123]
    s_waitcnt vmcnt(2)
    v_mfma_f32_32x32x16_bf16 v[44:59], a[68:71], v[16:19], v[44:59]
    s_nop 11
    v_exp_f32 v44, v44
    v_exp_f32 v45, v45
    v_exp_f32 v46, v46
    v_exp_f32 v47, v47
    v_exp_f32 v48, v48
    v_exp_f32 v49, v49
    v_exp_f32 v50, v50
    v_exp_f32 v51, v51
    v_exp_f32 v52, v52
    v_exp_f32 v53, v53
    v_exp_f32 v54, v54
    v_exp_f32 v55, v55
    v_exp_f32 v56, v56
    v_exp_f32 v57, v57
    v_exp_f32 v58, v58
    v_exp_f32 v59, v59
    s_waitcnt vmcnt(1)
    v_smfmac_f32_32x32x32_bf16 v[196:211], a[72:75], v[44:51], v11
    s_waitcnt vmcnt(0)
    v_smfmac_f32_32x32x32_bf16 v[196:211], a[76:79], v[52:59], v11
    s_nop 7
    s_sub_u32 s54, s54, 1
    s_cmp_lg_u32 s54, 0
    s_cbranch_scc1 L_slow_pv
    s_nop 7
    v_mov_b32 v3, v208
    v_mov_b32 v4, v208
    s_nop 1
    v_permlane32_swap_b32 v3, v4
    s_branch L_slow_ret
.section .rodata,"a"
.p2align 6
.amdhsa_kernel sequential_preLN__softmax_full_mha__mixer_channel_mlp__prompt_kernel
  .amdhsa_next_free_vgpr 512
  .amdhsa_next_free_sgpr 102
  .amdhsa_accum_offset 256
  .amdhsa_group_segment_fixed_size 0
  .amdhsa_kernarg_size 88
  .amdhsa_user_sgpr_count 2
  .amdhsa_user_sgpr_kernarg_segment_ptr 1
  .amdhsa_system_sgpr_workgroup_id_x 1
.end_amdhsa_kernel
```
